```python
import torch

def _softmax(x, axis=-1):
    return torch.softmax(x, dim=axis)
def _gelu(x):
    return torch.nn.functional.gelu(x, approximate="tanh")
def _silu(x):
    return torch.nn.functional.silu(x)
def _sigmoid(x):
    return torch.sigmoid(x)
def _layernorm(x, axis=-1, eps=1e-5):
    m = x.mean(dim=axis, keepdim=True)
    v = x.var(dim=axis, keepdim=True, unbiased=False)
    return (x - m) / torch.sqrt(v + eps)
def _scatter_add(tgt, idx, src, axis=0):
    return tgt.clone().index_add_(axis, idx, src)
def _segment_sum(src, seg, n):
    out = torch.zeros((n,) + src.shape[1:], dtype=src.dtype)
    return out.index_add_(0, seg, src)
def _pad(x, pw):
    flat = tuple(v for pair in reversed(pw) for v in pair)
    return torch.nn.functional.pad(x, flat)

kernel_name = 'parallel_sum__mha_block__dense_activation_relu__prompt'

def setup_inputs():

    _w = (lambda a: (lambda t: t.to(torch.bfloat16) if t.is_floating_point() else t)(torch.as_tensor(a)))
    def _A_setup():
        B, S, D, H = 1, 2048, 512, 32
        return {
            "x": _w((lambda *s: torch.randn(*s, dtype=torch.bfloat16) * 0.05)(B, S, D)),
            "wqkv": _w((lambda *s: torch.randn(*s, dtype=torch.bfloat16) * 0.2)(D, 3 * D)),
            "wo": _w((lambda *s: torch.randn(*s, dtype=torch.bfloat16) * 0.1)(D, D)),
        }
    _A_in = _A_setup()

    def _B_setup():
        B, S, D, Dff = 1, 2048, 512, 1792
        return {
            "x": _w((lambda *s: torch.randn(*s, dtype=torch.bfloat16) * 0.05)(B, S, D)),
            "w1": _w((lambda *s: torch.randn(*s, dtype=torch.bfloat16) * 0.2)(D, Dff)),
            "w2": _w((lambda *s: torch.randn(*s, dtype=torch.bfloat16) * 0.2)(Dff, D)),
        }
    _B_in = _B_setup()

    return {
        "A_x": _A_in["x"],
        "A_wqkv": _A_in["wqkv"],
        "A_wo": _A_in["wo"],
        "B_x": _B_in["x"],
        "B_w1": _B_in["w1"],
        "B_w2": _B_in["w2"],
    }

def reference(A_x, A_wqkv, A_wo, B_x, B_w1, B_w2):
    def _A_ref(x, wqkv, wo):
        B, S, D = x.shape
        H = 32
        Dh = D // H
        qkv = (lambda x, *d: x.permute(*d))((x @ wqkv).reshape(B, S, 3, H, Dh), 2, 0, 3, 1, 4)
        q, k, v = qkv[0], qkv[1], qkv[2]
        scores = torch.einsum("bhqd,bhkd->bhqk", q, k) * (Dh ** -0.5)
        p = _softmax(scores, axis=-1)
        o = torch.einsum("bhqk,bhkd->bhqd", p, v)
        return (lambda x, *d: x.permute(*d))(o, 0, 2, 1, 3).reshape(B, S, D) @ wo

    def _B_ref(x, w1, w2):
        h = torch.einsum("bsd,df->bsf", x, w1)
        zero = torch.zeros_like(h)
        h = torch.maximum(h, zero)
        return torch.einsum("bsf,fd->bsd", h, w2)

    x = A_x
    xn = _layernorm(x, axis=-1)
    return x + _A_ref(xn, A_wqkv, A_wo) + _B_ref(xn, B_w1, B_w2)
```

```asm
; @launch kernel=lngemm_kernel grid=(256,1,1) block=(256,1,1) lds=161792
; @launch kernel=attn_kernel grid=(256,1,1) block=(768,1,1) lds=155968
; @launch kernel=outgemm_kernel grid=(256,1,1) block=(256,1,1) lds=131072
.amdgcn_target "amdgcn-amd-amdhsa--gfx950"
.text
.globl lngemm_kernel
.p2align 8
.type lngemm_kernel,@function
lngemm_kernel:
    s_cmp_ge_u32 s2, 256
    s_cbranch_scc1 LA_exit
    s_load_dwordx4 s[4:7], s[0:1], 0
    s_load_dwordx2 s[8:9], s[0:1], 32
    s_load_dwordx2 s[10:11], s[0:1], 64
    s_load_dwordx2 s[44:45], s[0:1], 16
    s_load_dwordx2 s[46:47], s[0:1], 40
    s_getpc_b64 s[60:61]
LA_pc:
    s_bfe_u32 s62, s2, 0x10003
    s_lshl_b32 s62, s62, 15
    v_lshlrev_b32 v226, 7, v0
    v_add_u32 v226, s62, v226
    v_min_u32 v226, LC_exit-LA_pc, v226
    global_load_dword v227, v226, s[60:61]
    v_and_b32 v1, 63, v0
    v_lshrrev_b32 v4, 6, v0
    s_nop 0
    v_readfirstlane_b32 s26, v4
    s_bfe_u32 s24, s2, 0x20001
    s_lshl_b32 s24, s24, 2
    s_bfe_u32 s25, s2, 0x20003
    s_add_u32 s24, s24, s25
    s_and_b32 s25, s2, 1
    s_lshl_b32 s25, s25, 2
    s_bfe_u32 s28, s2, 0x20005
    s_add_u32 s25, s25, s28
    v_and_b32 v2, 31, v1
    v_lshrrev_b32 v3, 5, v1
    s_lshl_b32 s28, s24, 7
    s_lshl_b32 s29, s26, 5
    s_add_u32 s28, s28, s29
    v_add_u32 v2, s28, v2
    v_lshrrev_b32 v6, 3, v1
    v_lshrrev_b32 v7, 4, v1
    v_and_b32 v4, 7, v1
    v_xor_b32 v4, v4, v7
    v_xor_b32 v5, 4, v4
    v_lshlrev_b32 v6, 10, v6
    v_lshl_add_u32 v4, v4, 4, v6
    v_lshl_add_u32 v5, v5, 4, v6
    s_lshl_b32 s52, s28, 10
    s_lshl_b32 s53, s26, 12
    s_bfe_u32 s63, s2, 0x20005
    s_add_u32 s31, s63, 0
    s_and_b32 s31, s31, 3
    s_lshl_b32 s31, s31, 7
    s_add_u32 s64, s52, s31
    s_add_u32 s31, s63, 1
    s_and_b32 s31, s31, 3
    s_lshl_b32 s31, s31, 7
    s_add_u32 s65, s52, s31
    s_add_u32 s31, s63, 2
    s_and_b32 s31, s31, 3
    s_lshl_b32 s31, s31, 7
    s_add_u32 s66, s52, s31
    s_add_u32 s31, s63, 3
    s_and_b32 s31, s31, 3
    s_lshl_b32 s31, s31, 7
    s_add_u32 s67, s52, s31
    s_waitcnt lgkmcnt(0)
    s_mov_b32 s12, s4
    s_mov_b32 s13, s5
    s_mov_b32 s14, 2097152
    s_mov_b32 s15, 0x00020000
    s_add_u32 m0, s53, 0
    s_add_u32 s31, s64, 0
    buffer_load_dwordx4 v4, s[12:15], s31 offen lds
    s_add_u32 m0, s53, 1024
    s_add_u32 s31, s64, 8192
    buffer_load_dwordx4 v5, s[12:15], s31 offen lds
    s_add_u32 m0, s53, 2048
    s_add_u32 s31, s64, 16384
    buffer_load_dwordx4 v4, s[12:15], s31 offen lds
    s_add_u32 m0, s53, 3072
    s_add_u32 s31, s64, 24576
    buffer_load_dwordx4 v5, s[12:15], s31 offen lds
    s_add_u32 m0, s53, 16384
    s_add_u32 s31, s64, 512
    buffer_load_dwordx4 v4, s[12:15], s31 offen lds
    s_add_u32 m0, s53, 17408
    s_add_u32 s31, s64, 8704
    buffer_load_dwordx4 v5, s[12:15], s31 offen lds
    s_add_u32 m0, s53, 18432
    s_add_u32 s31, s64, 16896
    buffer_load_dwordx4 v4, s[12:15], s31 offen lds
    s_add_u32 m0, s53, 19456
    s_add_u32 s31, s64, 25088
    buffer_load_dwordx4 v5, s[12:15], s31 offen lds
    s_add_u32 m0, s53, 32768
    s_add_u32 s31, s65, 0
    buffer_load_dwordx4 v4, s[12:15], s31 offen lds
    s_add_u32 m0, s53, 33792
    s_add_u32 s31, s65, 8192
    buffer_load_dwordx4 v5, s[12:15], s31 offen lds
    s_add_u32 m0, s53, 34816
    s_add_u32 s31, s65, 16384
    buffer_load_dwordx4 v4, s[12:15], s31 offen lds
    s_add_u32 m0, s53, 35840
    s_add_u32 s31, s65, 24576
    buffer_load_dwordx4 v5, s[12:15], s31 offen lds
    s_add_u32 m0, s53, 49152
    s_add_u32 s31, s65, 512
    buffer_load_dwordx4 v4, s[12:15], s31 offen lds
    s_add_u32 m0, s53, 50176
    s_add_u32 s31, s65, 8704
    buffer_load_dwordx4 v5, s[12:15], s31 offen lds
    s_add_u32 m0, s53, 51200
    s_add_u32 s31, s65, 16896
    buffer_load_dwordx4 v4, s[12:15], s31 offen lds
    s_add_u32 m0, s53, 52224
    s_add_u32 s31, s65, 25088
    buffer_load_dwordx4 v5, s[12:15], s31 offen lds
    v_and_b32 v6, 7, v1
    v_lshlrev_b32 v6, 7, v6
    v_bfe_u32 v7, v1, 3, 2
    v_lshl_add_u32 v6, v7, 10, v6
    v_lshl_add_u32 v6, v3, 14, v6
    v_add_u32 v6, s53, v6
    v_bfe_u32 v7, v1, 1, 3
    v_xor_b32 v8, 0, v7
    v_lshl_add_u32 v8, v8, 4, v6
    v_xor_b32 v9, 1, v7
    v_lshl_add_u32 v9, v9, 4, v6
    v_xor_b32 v10, 2, v7
    v_lshl_add_u32 v10, v10, 4, v6
    v_xor_b32 v11, 3, v7
    v_lshl_add_u32 v11, v11, 4, v6
    v_xor_b32 v12, 4, v7
    v_lshl_add_u32 v12, v12, 4, v6
    v_xor_b32 v13, 5, v7
    v_lshl_add_u32 v13, v13, 4, v6
    v_xor_b32 v14, 6, v7
    v_lshl_add_u32 v14, v14, 4, v6
    v_xor_b32 v15, 7, v7
    v_lshl_add_u32 v15, v15, 4, v6
    s_lshl_b32 s48, s2, 2
    s_add_u32 s48, s48, s26
    v_lshrrev_b32 v6, 2, v1
    v_lshlrev_b32 v6, 10, v6
    v_and_b32 v7, 3, v1
    v_lshl_add_u32 v6, v7, 4, v6
    s_mov_b32 s39, 0x00020000
    s_sub_u32 s49, s48, 768
    s_cmp_ge_u32 s48, 768
    s_cselect_b32 s48, s49, s48
    s_add_u32 s49, s48, 0
    s_lshr_b32 s50, s49, 4
    s_and_b32 s51, s49, 15
    s_cmp_lt_u32 s50, 32
    s_cselect_b32 s36, s44, s46
    s_cselect_b32 s37, s45, s47
    s_mov_b32 s38, 524288
    s_cselect_b32 s38, s38, 1835008
    s_cselect_b32 s54, 0, 32
    s_sub_u32 s50, s50, s54
    s_lshl_b32 s50, s50, 14
    s_lshl_b32 s51, s51, 6
    s_add_u32 s50, s50, s51
    buffer_load_dwordx4 v[232:235], v6, s[36:39], s50 offen
    s_add_u32 s49, s48, 768
    s_lshr_b32 s50, s49, 4
    s_and_b32 s51, s49, 15
    s_cmp_lt_u32 s50, 32
    s_cselect_b32 s36, s44, s46
    s_cselect_b32 s37, s45, s47
    s_mov_b32 s38, 524288
    s_cselect_b32 s38, s38, 1835008
    s_cselect_b32 s54, 0, 32
    s_sub_u32 s50, s50, s54
    s_lshl_b32 s50, s50, 14
    s_lshl_b32 s51, s51, 6
    s_add_u32 s50, s50, s51
    buffer_load_dwordx4 v[236:239], v6, s[36:39], s50 offen
    s_add_u32 s49, s48, 1536
    s_lshr_b32 s50, s49, 4
    s_and_b32 s51, s49, 15
    s_cmp_lt_u32 s50, 32
    s_cselect_b32 s36, s44, s46
    s_cselect_b32 s37, s45, s47
    s_mov_b32 s38, 524288
    s_cselect_b32 s38, s38, 1835008
    s_cselect_b32 s54, 0, 32
    s_sub_u32 s50, s50, s54
    s_lshl_b32 s50, s50, 14
    s_lshl_b32 s51, s51, 6
    s_add_u32 s50, s50, s51
    buffer_load_dwordx4 v[240:243], v6, s[36:39], s50 offen
    s_cmp_ge_u32 s2, 128
    s_cbranch_scc1 LA_ffn
    s_mov_b32 s16, s6
    s_mov_b32 s17, s7
    s_mov_b32 s18, 1572864
    s_mov_b32 s19, 0x00020000
    s_mov_b32 s20, s10
    s_mov_b32 s21, s11
    s_mov_b32 s22, 6291456
    s_mov_b32 s23, 0x00020000
    s_mul_i32 s27, s25, 384
    s_mul_i32 s28, s26, 384
    v_add_u32 v218, s28, v1
    s_mov_b32 s29, 10923
    v_add_u32 v219, 0, v218
    v_mul_lo_u32 v220, v219, s29
    v_lshrrev_b32 v220, 18, v220
    v_mul_u32_u24 v221, 24, v220
    v_sub_u32 v221, v219, v221
    v_and_b32 v222, 2, v220
    v_lshlrev_b32 v222, 1, v222
    v_xor_b32 v221, v221, v222
    v_lshrrev_b32 v222, 5, v220
    v_lshlrev_b32 v222, 8, v222
    v_and_b32 v223, 31, v220
    v_add_u32 v222, v222, v223
    v_mul_u32_u24 v222, 3072, v222
    v_lshl_add_u32 v222, v221, 4, v222
    v_add_u32 v200, s27, v222
    v_add_u32 v219, 64, v218
    v_mul_lo_u32 v220, v219, s29
    v_lshrrev_b32 v220, 18, v220
    v_mul_u32_u24 v221, 24, v220
    v_sub_u32 v221, v219, v221
    v_and_b32 v222, 2, v220
    v_lshlrev_b32 v222, 1, v222
    v_xor_b32 v221, v221, v222
    v_lshrrev_b32 v222, 5, v220
    v_lshlrev_b32 v222, 8, v222
    v_and_b32 v223, 31, v220
    v_add_u32 v222, v222, v223
    v_mul_u32_u24 v222, 3072, v222
    v_lshl_add_u32 v222, v221, 4, v222
    v_add_u32 v201, s27, v222
    v_add_u32 v219, 128, v218
    v_mul_lo_u32 v220, v219, s29
    v_lshrrev_b32 v220, 18, v220
    v_mul_u32_u24 v221, 24, v220
    v_sub_u32 v221, v219, v221
    v_and_b32 v222, 2, v220
    v_lshlrev_b32 v222, 1, v222
    v_xor_b32 v221, v221, v222
    v_lshrrev_b32 v222, 5, v220
    v_lshlrev_b32 v222, 8, v222
    v_and_b32 v223, 31, v220
    v_add_u32 v222, v222, v223
    v_mul_u32_u24 v222, 3072, v222
    v_lshl_add_u32 v222, v221, 4, v222
    v_add_u32 v202, s27, v222
    v_add_u32 v219, 192, v218
    v_mul_lo_u32 v220, v219, s29
    v_lshrrev_b32 v220, 18, v220
    v_mul_u32_u24 v221, 24, v220
    v_sub_u32 v221, v219, v221
    v_and_b32 v222, 2, v220
    v_lshlrev_b32 v222, 1, v222
    v_xor_b32 v221, v221, v222
    v_lshrrev_b32 v222, 5, v220
    v_lshlrev_b32 v222, 8, v222
    v_and_b32 v223, 31, v220
    v_add_u32 v222, v222, v223
    v_mul_u32_u24 v222, 3072, v222
    v_lshl_add_u32 v222, v221, 4, v222
    v_add_u32 v203, s27, v222
    v_add_u32 v219, 256, v218
    v_mul_lo_u32 v220, v219, s29
    v_lshrrev_b32 v220, 18, v220
    v_mul_u32_u24 v221, 24, v220
    v_sub_u32 v221, v219, v221
    v_and_b32 v222, 2, v220
    v_lshlrev_b32 v222, 1, v222
    v_xor_b32 v221, v221, v222
    v_lshrrev_b32 v222, 5, v220
    v_lshlrev_b32 v222, 8, v222
    v_and_b32 v223, 31, v220
    v_add_u32 v222, v222, v223
    v_mul_u32_u24 v222, 3072, v222
    v_lshl_add_u32 v222, v221, 4, v222
    v_add_u32 v204, s27, v222
    v_add_u32 v219, 320, v218
    v_mul_lo_u32 v220, v219, s29
    v_lshrrev_b32 v220, 18, v220
    v_mul_u32_u24 v221, 24, v220
    v_sub_u32 v221, v219, v221
    v_and_b32 v222, 2, v220
    v_lshlrev_b32 v222, 1, v222
    v_xor_b32 v221, v221, v222
    v_lshrrev_b32 v222, 5, v220
    v_lshlrev_b32 v222, 8, v222
    v_and_b32 v223, 31, v220
    v_add_u32 v222, v222, v223
    v_mul_u32_u24 v222, 3072, v222
    v_lshl_add_u32 v222, v221, 4, v222
    v_add_u32 v205, s27, v222
    v_lshrrev_b32 v218, 5, v1
    v_lshlrev_b32 v218, 5, v218
    v_bfe_u32 v219, v1, 2, 2
    v_add_u32 v218, v218, v219
    v_mul_u32_u24 v218, 384, v218
    v_bfe_u32 v220, v1, 4, 1
    v_lshl_add_u32 v218, v220, 5, v218
    v_and_b32 v220, 3, v1
    v_lshl_add_u32 v218, v220, 3, v218
    v_and_b32 v219, 2, v219
    v_lshlrev_b32 v219, 5, v219
    v_add_u32 v208, v218, v219
    v_sub_u32 v209, v218, v219
    v_add_u32 v208, 133120, v208
    v_add_u32 v209, 133120, v209
    v_add_u32 v210, v218, v219
    v_sub_u32 v211, v218, v219
    v_add_u32 v210, 0, v210
    v_add_u32 v211, 0, v211
    v_add_u32 v212, v218, v219
    v_sub_u32 v213, v218, v219
    v_add_u32 v212, 24576, v212
    v_add_u32 v213, 24576, v213
    v_add_u32 v214, v218, v219
    v_sub_u32 v215, v218, v219
    v_add_u32 v214, 49152, v214
    v_add_u32 v215, 49152, v215
    s_mul_i32 s30, s26, 6144
    s_lshl_b32 s31, s63, 1
    s_add_u32 s31, s31, 0
    s_and_b32 s31, s31, 7
    s_mul_i32 s68, s31, 98304
    s_lshl_b32 s31, s63, 1
    s_add_u32 s31, s31, 1
    s_and_b32 s31, s31, 7
    s_mul_i32 s69, s31, 98304
    s_lshl_b32 s31, s63, 1
    s_add_u32 s31, s31, 2
    s_and_b32 s31, s31, 7
    s_mul_i32 s70, s31, 98304
    s_lshl_b32 s31, s63, 1
    s_add_u32 s31, s31, 3
    s_and_b32 s31, s31, 7
    s_mul_i32 s71, s31, 98304
    s_lshl_b32 s31, s63, 1
    s_add_u32 s31, s31, 4
    s_and_b32 s31, s31, 7
    s_mul_i32 s72, s31, 98304
    s_lshl_b32 s31, s63, 1
    s_add_u32 s31, s31, 5
    s_and_b32 s31, s31, 7
    s_mul_i32 s73, s31, 98304
    s_lshl_b32 s31, s63, 1
    s_add_u32 s31, s31, 6
    s_and_b32 s31, s31, 7
    s_mul_i32 s74, s31, 98304
    s_lshl_b32 s31, s63, 1
    s_add_u32 s31, s31, 7
    s_and_b32 s31, s31, 7
    s_mul_i32 s75, s31, 98304
    v_mov_b32 v218, 0
    v_mov_b32 v219, 0
    v_mov_b32 v220, 0
    v_mov_b32 v221, 0
    v_mov_b32 v222, 0x3f803f80
    s_add_u32 s28, s53, 98304
    v_lshlrev_b32 v223, 4, v1
    v_add_u32 v223, s28, v223
    v_bfe_u32 v224, v1, 2, 2
    v_lshl_add_u32 v224, v3, 3, v224
    v_lshlrev_b32 v224, 6, v224
    v_bfe_u32 v225, v1, 4, 1
    v_lshl_add_u32 v224, v225, 5, v224
    v_and_b32 v225, 3, v1
    v_lshl_add_u32 v224, v225, 3, v224
    v_add_u32 v224, s28, v224
    v_and_b32 v225, 31, v1
    v_lshlrev_b32 v225, 4, v225
    v_lshl_add_u32 v225, v3, 13, v225
    s_add_u32 s40, s10, 20971520
    s_addc_u32 s41, s11, 0
    s_mov_b32 s42, 2359296
    s_mov_b32 s43, 0x00020000
    s_waitcnt vmcnt(11)
    ds_read_b128 v[16:19], v8 offset:0
    ds_read_b128 v[20:23], v9 offset:0
    ds_read_b128 v[24:27], v10 offset:0
    ds_read_b128 v[28:31], v11 offset:0
    ds_read_b128 v[32:35], v12 offset:0
    ds_read_b128 v[36:39], v13 offset:0
    ds_read_b128 v[40:43], v14 offset:0
    ds_read_b128 v[44:47], v15 offset:0
    s_waitcnt lgkmcnt(7)
    v_dot2_f32_bf16 v218, v16, v222, v218
    v_dot2_f32_bf16 v220, v16, v16, v220
    v_dot2_f32_bf16 v219, v17, v222, v219
    v_dot2_f32_bf16 v221, v17, v17, v221
    s_add_u32 m0, s53, 65536
    s_add_u32 s31, s66, 0
    buffer_load_dwordx4 v4, s[12:15], s31 offen lds
    v_dot2_f32_bf16 v218, v18, v222, v218
    v_dot2_f32_bf16 v220, v18, v18, v220
    v_dot2_f32_bf16 v219, v19, v222, v219
    v_dot2_f32_bf16 v221, v19, v19, v221
    s_add_u32 m0, s53, 66560
    s_add_u32 s31, s66, 8192
    buffer_load_dwordx4 v5, s[12:15], s31 offen lds
    s_waitcnt lgkmcnt(6)
    v_dot2_f32_bf16 v218, v20, v222, v218
    v_dot2_f32_bf16 v220, v20, v20, v220
    v_dot2_f32_bf16 v219, v21, v222, v219
    v_dot2_f32_bf16 v221, v21, v21, v221
    s_add_u32 m0, s53, 67584
    s_add_u32 s31, s66, 16384
    buffer_load_dwordx4 v4, s[12:15], s31 offen lds
    v_dot2_f32_bf16 v218, v22, v222, v218
    v_dot2_f32_bf16 v220, v22, v22, v220
    v_dot2_f32_bf16 v219, v23, v222, v219
    v_dot2_f32_bf16 v221, v23, v23, v221
    s_add_u32 m0, s53, 68608
    s_add_u32 s31, s66, 24576
    buffer_load_dwordx4 v5, s[12:15], s31 offen lds
    s_waitcnt lgkmcnt(5)
    v_dot2_f32_bf16 v218, v24, v222, v218
    v_dot2_f32_bf16 v220, v24, v24, v220
    v_dot2_f32_bf16 v219, v25, v222, v219
    v_dot2_f32_bf16 v221, v25, v25, v221
    s_add_u32 m0, s53, 81920
    s_add_u32 s31, s66, 512
    buffer_load_dwordx4 v4, s[12:15], s31 offen lds
    v_dot2_f32_bf16 v218, v26, v222, v218
    v_dot2_f32_bf16 v220, v26, v26, v220
    v_dot2_f32_bf16 v219, v27, v222, v219
    v_dot2_f32_bf16 v221, v27, v27, v221
    s_add_u32 m0, s53, 82944
    s_add_u32 s31, s66, 8704
    buffer_load_dwordx4 v5, s[12:15], s31 offen lds
    s_waitcnt lgkmcnt(4)
    v_dot2_f32_bf16 v218, v28, v222, v218
    v_dot2_f32_bf16 v220, v28, v28, v220
    v_dot2_f32_bf16 v219, v29, v222, v219
    v_dot2_f32_bf16 v221, v29, v29, v221
    s_add_u32 m0, s53, 83968
    s_add_u32 s31, s66, 16896
    buffer_load_dwordx4 v4, s[12:15], s31 offen lds
    v_dot2_f32_bf16 v218, v30, v222, v218
    v_dot2_f32_bf16 v220, v30, v30, v220
    v_dot2_f32_bf16 v219, v31, v222, v219
    v_dot2_f32_bf16 v221, v31, v31, v221
    s_add_u32 m0, s53, 84992
    s_add_u32 s31, s66, 25088
    buffer_load_dwordx4 v5, s[12:15], s31 offen lds
    s_waitcnt lgkmcnt(3)
    v_dot2_f32_bf16 v218, v32, v222, v218
    v_dot2_f32_bf16 v220, v32, v32, v220
    v_dot2_f32_bf16 v219, v33, v222, v219
    v_dot2_f32_bf16 v221, v33, v33, v221
    v_dot2_f32_bf16 v218, v34, v222, v218
    v_dot2_f32_bf16 v220, v34, v34, v220
    v_dot2_f32_bf16 v219, v35, v222, v219
    v_dot2_f32_bf16 v221, v35, v35, v221
    s_waitcnt lgkmcnt(2)
    v_dot2_f32_bf16 v218, v36, v222, v218
    v_dot2_f32_bf16 v220, v36, v36, v220
    v_dot2_f32_bf16 v219, v37, v222, v219
    v_dot2_f32_bf16 v221, v37, v37, v221
    v_dot2_f32_bf16 v218, v38, v222, v218
    v_dot2_f32_bf16 v220, v38, v38, v220
    v_dot2_f32_bf16 v219, v39, v222, v219
    v_dot2_f32_bf16 v221, v39, v39, v221
    s_waitcnt lgkmcnt(1)
    v_dot2_f32_bf16 v218, v40, v222, v218
    v_dot2_f32_bf16 v220, v40, v40, v220
    v_dot2_f32_bf16 v219, v41, v222, v219
    v_dot2_f32_bf16 v221, v41, v41, v221
    v_dot2_f32_bf16 v218, v42, v222, v218
    v_dot2_f32_bf16 v220, v42, v42, v220
    v_dot2_f32_bf16 v219, v43, v222, v219
    v_dot2_f32_bf16 v221, v43, v43, v221
    s_waitcnt lgkmcnt(0)
    v_dot2_f32_bf16 v218, v44, v222, v218
    v_dot2_f32_bf16 v220, v44, v44, v220
    v_dot2_f32_bf16 v219, v45, v222, v219
    v_dot2_f32_bf16 v221, v45, v45, v221
    v_dot2_f32_bf16 v218, v46, v222, v218
    v_dot2_f32_bf16 v220, v46, v46, v220
    v_dot2_f32_bf16 v219, v47, v222, v219
    v_dot2_f32_bf16 v221, v47, v47, v221
    s_waitcnt vmcnt(11)
    ds_read_b128 v[48:51], v8 offset:32768
    ds_read_b128 v[52:55], v9 offset:32768
    ds_read_b128 v[56:59], v10 offset:32768
    ds_read_b128 v[60:63], v11 offset:32768
    ds_read_b128 v[64:67], v12 offset:32768
    ds_read_b128 v[68:71], v13 offset:32768
    ds_read_b128 v[72:75], v14 offset:32768
    ds_read_b128 v[76:79], v15 offset:32768
    s_waitcnt lgkmcnt(7)
    v_dot2_f32_bf16 v218, v48, v222, v218
    v_dot2_f32_bf16 v220, v48, v48, v220
    v_dot2_f32_bf16 v219, v49, v222, v219
    v_dot2_f32_bf16 v221, v49, v49, v221
    s_add_u32 m0, s53, 98304
    s_add_u32 s31, s67, 0
    buffer_load_dwordx4 v4, s[12:15], s31 offen lds
    v_dot2_f32_bf16 v218, v50, v222, v218
    v_dot2_f32_bf16 v220, v50, v50, v220
    v_dot2_f32_bf16 v219, v51, v222, v219
    v_dot2_f32_bf16 v221, v51, v51, v221
    s_add_u32 m0, s53, 99328
    s_add_u32 s31, s67, 8192
    buffer_load_dwordx4 v5, s[12:15], s31 offen lds
    s_waitcnt lgkmcnt(6)
    v_dot2_f32_bf16 v218, v52, v222, v218
    v_dot2_f32_bf16 v220, v52, v52, v220
    v_dot2_f32_bf16 v219, v53, v222, v219
    v_dot2_f32_bf16 v221, v53, v53, v221
    s_add_u32 m0, s53, 100352
    s_add_u32 s31, s67, 16384
    buffer_load_dwordx4 v4, s[12:15], s31 offen lds
    v_dot2_f32_bf16 v218, v54, v222, v218
    v_dot2_f32_bf16 v220, v54, v54, v220
    v_dot2_f32_bf16 v219, v55, v222, v219
    v_dot2_f32_bf16 v221, v55, v55, v221
    s_add_u32 m0, s53, 101376
    s_add_u32 s31, s67, 24576
    buffer_load_dwordx4 v5, s[12:15], s31 offen lds
    s_waitcnt lgkmcnt(5)
    v_dot2_f32_bf16 v218, v56, v222, v218
    v_dot2_f32_bf16 v220, v56, v56, v220
    v_dot2_f32_bf16 v219, v57, v222, v219
    v_dot2_f32_bf16 v221, v57, v57, v221
    s_add_u32 m0, s53, 114688
    s_add_u32 s31, s67, 512
    buffer_load_dwordx4 v4, s[12:15], s31 offen lds
    v_dot2_f32_bf16 v218, v58, v222, v218
    v_dot2_f32_bf16 v220, v58, v58, v220
    v_dot2_f32_bf16 v219, v59, v222, v219
    v_dot2_f32_bf16 v221, v59, v59, v221
    s_add_u32 m0, s53, 115712
    s_add_u32 s31, s67, 8704
    buffer_load_dwordx4 v5, s[12:15], s31 offen lds
    s_waitcnt lgkmcnt(4)
    v_dot2_f32_bf16 v218, v60, v222, v218
    v_dot2_f32_bf16 v220, v60, v60, v220
    v_dot2_f32_bf16 v219, v61, v222, v219
    v_dot2_f32_bf16 v221, v61, v61, v221
    s_add_u32 m0, s53, 116736
    s_add_u32 s31, s67, 16896
    buffer_load_dwordx4 v4, s[12:15], s31 offen lds
    v_dot2_f32_bf16 v218, v62, v222, v218
    v_dot2_f32_bf16 v220, v62, v62, v220
    v_dot2_f32_bf16 v219, v63, v222, v219
    v_dot2_f32_bf16 v221, v63, v63, v221
    s_add_u32 m0, s53, 117760
    s_add_u32 s31, s67, 25088
    buffer_load_dwordx4 v5, s[12:15], s31 offen lds
    s_waitcnt lgkmcnt(3)
    v_dot2_f32_bf16 v218, v64, v222, v218
    v_dot2_f32_bf16 v220, v64, v64, v220
    v_dot2_f32_bf16 v219, v65, v222, v219
    v_dot2_f32_bf16 v221, v65, v65, v221
    v_dot2_f32_bf16 v218, v66, v222, v218
    v_dot2_f32_bf16 v220, v66, v66, v220
    v_dot2_f32_bf16 v219, v67, v222, v219
    v_dot2_f32_bf16 v221, v67, v67, v221
    s_waitcnt lgkmcnt(2)
    v_dot2_f32_bf16 v218, v68, v222, v218
    v_dot2_f32_bf16 v220, v68, v68, v220
    v_dot2_f32_bf16 v219, v69, v222, v219
    v_dot2_f32_bf16 v221, v69, v69, v221
    v_dot2_f32_bf16 v218, v70, v222, v218
    v_dot2_f32_bf16 v220, v70, v70, v220
    v_dot2_f32_bf16 v219, v71, v222, v219
    v_dot2_f32_bf16 v221, v71, v71, v221
    s_waitcnt lgkmcnt(1)
    v_dot2_f32_bf16 v218, v72, v222, v218
    v_dot2_f32_bf16 v220, v72, v72, v220
    v_dot2_f32_bf16 v219, v73, v222, v219
    v_dot2_f32_bf16 v221, v73, v73, v221
    v_dot2_f32_bf16 v218, v74, v222, v218
    v_dot2_f32_bf16 v220, v74, v74, v220
    v_dot2_f32_bf16 v219, v75, v222, v219
    v_dot2_f32_bf16 v221, v75, v75, v221
    s_waitcnt lgkmcnt(0)
    v_dot2_f32_bf16 v218, v76, v222, v218
    v_dot2_f32_bf16 v220, v76, v76, v220
    v_dot2_f32_bf16 v219, v77, v222, v219
    v_dot2_f32_bf16 v221, v77, v77, v221
    v_dot2_f32_bf16 v218, v78, v222, v218
    v_dot2_f32_bf16 v220, v78, v78, v220
    v_dot2_f32_bf16 v219, v79, v222, v219
    v_dot2_f32_bf16 v221, v79, v79, v221
    s_barrier
    v_add_u32 v8, 65536, v8
    v_add_u32 v9, 65536, v9
    v_add_u32 v10, 65536, v10
    v_add_u32 v11, 65536, v11
    v_add_u32 v12, 65536, v12
    v_add_u32 v13, 65536, v13
    v_add_u32 v14, 65536, v14
    v_add_u32 v15, 65536, v15
    s_waitcnt vmcnt(8)
    ds_read_b128 v[80:83], v8 offset:0
    ds_read_b128 v[84:87], v9 offset:0
    ds_read_b128 v[88:91], v10 offset:0
    ds_read_b128 v[92:95], v11 offset:0
    ds_read_b128 v[96:99], v12 offset:0
    ds_read_b128 v[100:103], v13 offset:0
    ds_read_b128 v[104:107], v14 offset:0
    ds_read_b128 v[108:111], v15 offset:0
    s_waitcnt lgkmcnt(7)
    v_dot2_f32_bf16 v218, v80, v222, v218
    v_dot2_f32_bf16 v220, v80, v80, v220
    v_dot2_f32_bf16 v219, v81, v222, v219
    v_dot2_f32_bf16 v221, v81, v81, v221
    s_add_u32 m0, s30, 133120
    buffer_load_dwordx4 v200, s[16:19], s68 offen lds
    v_dot2_f32_bf16 v218, v82, v222, v218
    v_dot2_f32_bf16 v220, v82, v82, v220
    v_dot2_f32_bf16 v219, v83, v222, v219
    v_dot2_f32_bf16 v221, v83, v83, v221
    s_add_u32 m0, s30, 134144
    buffer_load_dwordx4 v201, s[16:19], s68 offen lds
    s_waitcnt lgkmcnt(6)
    v_dot2_f32_bf16 v218, v84, v222, v218
    v_dot2_f32_bf16 v220, v84, v84, v220
    v_dot2_f32_bf16 v219, v85, v222, v219
    v_dot2_f32_bf16 v221, v85, v85, v221
    s_add_u32 m0, s30, 135168
    buffer_load_dwordx4 v202, s[16:19], s68 offen lds
    v_dot2_f32_bf16 v218, v86, v222, v218
    v_dot2_f32_bf16 v220, v86, v86, v220
    v_dot2_f32_bf16 v219, v87, v222, v219
    v_dot2_f32_bf16 v221, v87, v87, v221
    s_add_u32 m0, s30, 136192
    buffer_load_dwordx4 v203, s[16:19], s68 offen lds
    s_waitcnt lgkmcnt(5)
    v_dot2_f32_bf16 v218, v88, v222, v218
    v_dot2_f32_bf16 v220, v88, v88, v220
    v_dot2_f32_bf16 v219, v89, v222, v219
    v_dot2_f32_bf16 v221, v89, v89, v221
    s_add_u32 m0, s30, 137216
    buffer_load_dwordx4 v204, s[16:19], s68 offen lds
    v_dot2_f32_bf16 v218, v90, v222, v218
    v_dot2_f32_bf16 v220, v90, v90, v220
    v_dot2_f32_bf16 v219, v91, v222, v219
    v_dot2_f32_bf16 v221, v91, v91, v221
    s_add_u32 m0, s30, 138240
    buffer_load_dwordx4 v205, s[16:19], s68 offen lds
    s_waitcnt lgkmcnt(4)
    v_dot2_f32_bf16 v218, v92, v222, v218
    v_dot2_f32_bf16 v220, v92, v92, v220
    v_dot2_f32_bf16 v219, v93, v222, v219
    v_dot2_f32_bf16 v221, v93, v93, v221
    v_dot2_f32_bf16 v218, v94, v222, v218
    v_dot2_f32_bf16 v220, v94, v94, v220
    v_dot2_f32_bf16 v219, v95, v222, v219
    v_dot2_f32_bf16 v221, v95, v95, v221
    s_waitcnt lgkmcnt(3)
    v_dot2_f32_bf16 v218, v96, v222, v218
    v_dot2_f32_bf16 v220, v96, v96, v220
    v_dot2_f32_bf16 v219, v97, v222, v219
    v_dot2_f32_bf16 v221, v97, v97, v221
    v_dot2_f32_bf16 v218, v98, v222, v218
    v_dot2_f32_bf16 v220, v98, v98, v220
    v_dot2_f32_bf16 v219, v99, v222, v219
    v_dot2_f32_bf16 v221, v99, v99, v221
    s_waitcnt lgkmcnt(2)
    v_dot2_f32_bf16 v218, v100, v222, v218
    v_dot2_f32_bf16 v220, v100, v100, v220
    v_dot2_f32_bf16 v219, v101, v222, v219
    v_dot2_f32_bf16 v221, v101, v101, v221
    v_dot2_f32_bf16 v218, v102, v222, v218
    v_dot2_f32_bf16 v220, v102, v102, v220
    v_dot2_f32_bf16 v219, v103, v222, v219
    v_dot2_f32_bf16 v221, v103, v103, v221
    s_waitcnt lgkmcnt(1)
    v_dot2_f32_bf16 v218, v104, v222, v218
    v_dot2_f32_bf16 v220, v104, v104, v220
    v_dot2_f32_bf16 v219, v105, v222, v219
    v_dot2_f32_bf16 v221, v105, v105, v221
    v_dot2_f32_bf16 v218, v106, v222, v218
    v_dot2_f32_bf16 v220, v106, v106, v220
    v_dot2_f32_bf16 v219, v107, v222, v219
    v_dot2_f32_bf16 v221, v107, v107, v221
    s_waitcnt lgkmcnt(0)
    v_dot2_f32_bf16 v218, v108, v222, v218
    v_dot2_f32_bf16 v220, v108, v108, v220
    v_dot2_f32_bf16 v219, v109, v222, v219
    v_dot2_f32_bf16 v221, v109, v109, v221
    v_dot2_f32_bf16 v218, v110, v222, v218
    v_dot2_f32_bf16 v220, v110, v110, v220
    v_dot2_f32_bf16 v219, v111, v222, v219
    v_dot2_f32_bf16 v221, v111, v111, v221
    s_waitcnt vmcnt(6)
    ds_read_b128 v[112:115], v8 offset:32768
    ds_read_b128 v[116:119], v9 offset:32768
    ds_read_b128 v[120:123], v10 offset:32768
    ds_read_b128 v[124:127], v11 offset:32768
    ds_read_b128 v[128:131], v12 offset:32768
    ds_read_b128 v[132:135], v13 offset:32768
    ds_read_b128 v[136:139], v14 offset:32768
    ds_read_b128 v[140:143], v15 offset:32768
    s_waitcnt lgkmcnt(7)
    v_dot2_f32_bf16 v218, v112, v222, v218
    v_dot2_f32_bf16 v220, v112, v112, v220
    v_dot2_f32_bf16 v219, v113, v222, v219
    v_dot2_f32_bf16 v221, v113, v113, v221
    s_add_u32 m0, s30, 0
    buffer_load_dwordx4 v200, s[16:19], s69 offen lds
    v_dot2_f32_bf16 v218, v114, v222, v218
    v_dot2_f32_bf16 v220, v114, v114, v220
    v_dot2_f32_bf16 v219, v115, v222, v219
    v_dot2_f32_bf16 v221, v115, v115, v221
    s_add_u32 m0, s30, 1024
    buffer_load_dwordx4 v201, s[16:19], s69 offen lds
    s_waitcnt lgkmcnt(6)
    v_dot2_f32_bf16 v218, v116, v222, v218
    v_dot2_f32_bf16 v220, v116, v116, v220
    v_dot2_f32_bf16 v219, v117, v222, v219
    v_dot2_f32_bf16 v221, v117, v117, v221
    s_add_u32 m0, s30, 2048
    buffer_load_dwordx4 v202, s[16:19], s69 offen lds
    v_dot2_f32_bf16 v218, v118, v222, v218
    v_dot2_f32_bf16 v220, v118, v118, v220
    v_dot2_f32_bf16 v219, v119, v222, v219
    v_dot2_f32_bf16 v221, v119, v119, v221
    s_add_u32 m0, s30, 3072
    buffer_load_dwordx4 v203, s[16:19], s69 offen lds
    s_waitcnt lgkmcnt(5)
    v_dot2_f32_bf16 v218, v120, v222, v218
    v_dot2_f32_bf16 v220, v120, v120, v220
    v_dot2_f32_bf16 v219, v121, v222, v219
    v_dot2_f32_bf16 v221, v121, v121, v221
    s_add_u32 m0, s30, 4096
    buffer_load_dwordx4 v204, s[16:19], s69 offen lds
    v_dot2_f32_bf16 v218, v122, v222, v218
    v_dot2_f32_bf16 v220, v122, v122, v220
    v_dot2_f32_bf16 v219, v123, v222, v219
    v_dot2_f32_bf16 v221, v123, v123, v221
    s_add_u32 m0, s30, 5120
    buffer_load_dwordx4 v205, s[16:19], s69 offen lds
    s_waitcnt lgkmcnt(4)
    v_dot2_f32_bf16 v218, v124, v222, v218
    v_dot2_f32_bf16 v220, v124, v124, v220
    v_dot2_f32_bf16 v219, v125, v222, v219
    v_dot2_f32_bf16 v221, v125, v125, v221
    s_add_u32 m0, s30, 24576
    buffer_load_dwordx4 v200, s[16:19], s70 offen lds
    v_dot2_f32_bf16 v218, v126, v222, v218
    v_dot2_f32_bf16 v220, v126, v126, v220
    v_dot2_f32_bf16 v219, v127, v222, v219
    v_dot2_f32_bf16 v221, v127, v127, v221
    s_add_u32 m0, s30, 25600
    buffer_load_dwordx4 v201, s[16:19], s70 offen lds
    s_waitcnt lgkmcnt(3)
    v_dot2_f32_bf16 v218, v128, v222, v218
    v_dot2_f32_bf16 v220, v128, v128, v220
    v_dot2_f32_bf16 v219, v129, v222, v219
    v_dot2_f32_bf16 v221, v129, v129, v221
    s_add_u32 m0, s30, 26624
    buffer_load_dwordx4 v202, s[16:19], s70 offen lds
    v_dot2_f32_bf16 v218, v130, v222, v218
    v_dot2_f32_bf16 v220, v130, v130, v220
    v_dot2_f32_bf16 v219, v131, v222, v219
    v_dot2_f32_bf16 v221, v131, v131, v221
    s_add_u32 m0, s30, 27648
    buffer_load_dwordx4 v203, s[16:19], s70 offen lds
    s_waitcnt lgkmcnt(2)
    v_dot2_f32_bf16 v218, v132, v222, v218
    v_dot2_f32_bf16 v220, v132, v132, v220
    v_dot2_f32_bf16 v219, v133, v222, v219
    v_dot2_f32_bf16 v221, v133, v133, v221
    s_add_u32 m0, s30, 28672
    buffer_load_dwordx4 v204, s[16:19], s70 offen lds
    v_dot2_f32_bf16 v218, v134, v222, v218
    v_dot2_f32_bf16 v220, v134, v134, v220
    v_dot2_f32_bf16 v219, v135, v222, v219
    v_dot2_f32_bf16 v221, v135, v135, v221
    s_add_u32 m0, s30, 29696
    buffer_load_dwordx4 v205, s[16:19], s70 offen lds
    s_waitcnt lgkmcnt(1)
    v_dot2_f32_bf16 v218, v136, v222, v218
    v_dot2_f32_bf16 v220, v136, v136, v220
    v_dot2_f32_bf16 v219, v137, v222, v219
    v_dot2_f32_bf16 v221, v137, v137, v221
    v_dot2_f32_bf16 v218, v138, v222, v218
    v_dot2_f32_bf16 v220, v138, v138, v220
    v_dot2_f32_bf16 v219, v139, v222, v219
    v_dot2_f32_bf16 v221, v139, v139, v221
    s_waitcnt lgkmcnt(0)
    v_dot2_f32_bf16 v218, v140, v222, v218
    v_dot2_f32_bf16 v220, v140, v140, v220
    v_dot2_f32_bf16 v219, v141, v222, v219
    v_dot2_f32_bf16 v221, v141, v141, v221
    v_dot2_f32_bf16 v218, v142, v222, v218
    v_dot2_f32_bf16 v220, v142, v142, v220
    v_dot2_f32_bf16 v219, v143, v222, v219
    v_dot2_f32_bf16 v221, v143, v143, v221
    ds_write_b128 v223, v[232:235] offset:0
    ds_write_b128 v223, v[236:239] offset:1024
    ds_write_b128 v223, v[240:243] offset:2048
    s_waitcnt lgkmcnt(0)
    ds_read_b64_tr_b16 v[232:233], v224 offset:0
    ds_read_b64_tr_b16 v[234:235], v224 offset:256
    ds_read_b64_tr_b16 v[236:237], v224 offset:1024
    ds_read_b64_tr_b16 v[238:239], v224 offset:1280
    ds_read_b64_tr_b16 v[240:241], v224 offset:2048
    ds_read_b64_tr_b16 v[242:243], v224 offset:2304
    s_nop 3
    v_add_f32 v218, v218, v219
    v_add_f32 v220, v220, v221
    v_mov_b32 v219, v218
    v_mov_b32 v221, v220
    s_nop 1
    v_permlane32_swap_b32 v218, v219
    v_permlane32_swap_b32 v220, v221
    s_nop 1
    v_add_f32 v218, v218, v219
    v_add_f32 v220, v220, v221
    v_mul_f32 v218, 0x3b000000, v218
    v_mul_f32 v220, 0x3b000000, v220
    v_fma_f32 v220, -v218, v218, v220
    v_max_f32 v220, 0, v220
    v_cvt_pk_bf16_f32 v218, v218, v220
    v_and_b32 v220, 0xffff0000, v218
    v_lshlrev_b32 v218, 16, v218
    v_add_f32 v220, 0x3727c5ac, v220
    v_cvt_pk_bf16_f32 v220, v220, v220
    v_and_b32 v220, 0xffff0000, v220
    v_sqrt_f32 v220, v220
    s_nop 0
    v_cvt_pk_bf16_f32 v220, v220, v220
    v_and_b32 v220, 0xffff0000, v220
    v_rcp_f32 v216, v220
    s_nop 0
    v_mul_f32 v217, v218, v216
    v_sub_f32 v217, 0, v217
    v_lshlrev_b32 v218, 16, v16
    v_and_b32 v219, 0xffff0000, v16
    v_fma_f32 v218, v218, v216, v217
    v_fma_f32 v219, v219, v216, v217
    v_cvt_pk_bf16_f32 v16, v218, v219
    v_lshlrev_b32 v220, 16, v17
    v_and_b32 v221, 0xffff0000, v17
    v_fma_f32 v220, v220, v216, v217
    v_fma_f32 v221, v221, v216, v217
    v_cvt_pk_bf16_f32 v17, v220, v221
    v_lshlrev_b32 v218, 16, v18
    v_and_b32 v219, 0xffff0000, v18
    v_fma_f32 v218, v218, v216, v217
    v_fma_f32 v219, v219, v216, v217
    v_cvt_pk_bf16_f32 v18, v218, v219
    v_lshlrev_b32 v220, 16, v19
    v_and_b32 v221, 0xffff0000, v19
    v_fma_f32 v220, v220, v216, v217
    v_fma_f32 v221, v221, v216, v217
    v_cvt_pk_bf16_f32 v19, v220, v221
    s_waitcnt lgkmcnt(0)
    s_add_u32 s49, s48, 0
    s_lshr_b32 s50, s49, 4
    s_and_b32 s51, s49, 15
    s_lshl_b32 s50, s50, 14
    s_lshl_b32 s51, s51, 9
    s_add_u32 s50, s50, s51
    buffer_store_dwordx4 v[232:235], v225, s[40:43], s50 offen sc1
    s_add_u32 s49, s48, 768
    s_lshr_b32 s50, s49, 4
    s_and_b32 s51, s49, 15
    s_lshl_b32 s50, s50, 14
    s_lshl_b32 s51, s51, 9
    s_add_u32 s50, s50, s51
    buffer_store_dwordx4 v[236:239], v225, s[40:43], s50 offen sc1
    s_add_u32 s49, s48, 1536
    s_lshr_b32 s50, s49, 4
    s_and_b32 s51, s49, 15
    s_lshl_b32 s50, s50, 14
    s_lshl_b32 s51, s51, 9
    s_add_u32 s50, s50, s51
    buffer_store_dwordx4 v[240:243], v225, s[40:43], s50 offen sc1
    s_waitcnt vmcnt(15)
    s_barrier
    ds_read_b64_tr_b16 v[144:145], v208 offset:0
    ds_read_b64_tr_b16 v[146:147], v208 offset:1536
    ds_read_b64_tr_b16 v[148:149], v209 offset:64
    ds_read_b64_tr_b16 v[150:151], v209 offset:1600
    ds_read_b64_tr_b16 v[152:153], v208 offset:128
    ds_read_b64_tr_b16 v[154:155], v208 offset:1664
    ds_read_b64_tr_b16 v[156:157], v209 offset:192
    ds_read_b64_tr_b16 v[158:159], v209 offset:1728
    ds_read_b64_tr_b16 v[160:161], v208 offset:256
    ds_read_b64_tr_b16 v[162:163], v208 offset:1792
    ds_read_b64_tr_b16 v[164:165], v209 offset:320
    ds_read_b64_tr_b16 v[166:167], v209 offset:1856
    s_waitcnt lgkmcnt(8)
    v_mfma_f32_32x32x16_bf16 a[0:15], v[144:147], v[16:19], 0
    ds_read_b64_tr_b16 v[172:173], v208 offset:3072
    ds_read_b64_tr_b16 v[174:175], v208 offset:4608
    v_lshlrev_b32 v218, 16, v20
    v_and_b32 v219, 0xffff0000, v20
    v_fma_f32 v218, v218, v216, v217
    v_fma_f32 v219, v219, v216, v217
    v_mfma_f32_32x32x16_bf16 a[16:31], v[148:151], v[16:19], 0
    ds_read_b64_tr_b16 v[176:177], v209 offset:3136
    ds_read_b64_tr_b16 v[178:179], v209 offset:4672
    v_cvt_pk_bf16_f32 v20, v218, v219
    v_lshlrev_b32 v220, 16, v21
    v_and_b32 v221, 0xffff0000, v21
    v_fma_f32 v220, v220, v216, v217
    s_waitcnt lgkmcnt(8)
    v_mfma_f32_32x32x16_bf16 a[32:47], v[152:155], v[16:19], 0
    ds_read_b64_tr_b16 v[180:181], v208 offset:3200
    ds_read_b64_tr_b16 v[182:183], v208 offset:4736
    v_fma_f32 v221, v221, v216, v217
    v_cvt_pk_bf16_f32 v21, v220, v221
    v_lshlrev_b32 v218, 16, v22
    v_and_b32 v219, 0xffff0000, v22
    v_mfma_f32_32x32x16_bf16 a[48:63], v[156:159], v[16:19], 0
    ds_read_b64_tr_b16 v[184:185], v209 offset:3264
    ds_read_b64_tr_b16 v[186:187], v209 offset:4800
    v_fma_f32 v218, v218, v216, v217
    v_fma_f32 v219, v219, v216, v217
    v_cvt_pk_bf16_f32 v22, v218, v219
    v_lshlrev_b32 v220, 16, v23
    s_waitcnt lgkmcnt(8)
    v_mfma_f32_32x32x16_bf16 a[64:79], v[160:163], v[16:19], 0
    ds_read_b64_tr_b16 v[188:189], v208 offset:3328
    ds_read_b64_tr_b16 v[190:191], v208 offset:4864
    v_and_b32 v221, 0xffff0000, v23
    v_fma_f32 v220, v220, v216, v217
    v_fma_f32 v221, v221, v216, v217
    v_cvt_pk_bf16_f32 v23, v220, v221
    v_mfma_f32_32x32x16_bf16 a[80:95], v[164:167], v[16:19], 0
    ds_read_b64_tr_b16 v[192:193], v209 offset:3392
    ds_read_b64_tr_b16 v[194:195], v209 offset:4928
    s_waitcnt lgkmcnt(8)
    v_mfma_f32_32x32x16_bf16 a[0:15], v[172:175], v[20:23], a[0:15]
    ds_read_b64_tr_b16 v[144:145], v208 offset:6144
    ds_read_b64_tr_b16 v[146:147], v208 offset:7680
    v_lshlrev_b32 v218, 16, v24
    v_and_b32 v219, 0xffff0000, v24
    v_fma_f32 v218, v218, v216, v217
    v_fma_f32 v219, v219, v216, v217
    v_mfma_f32_32x32x16_bf16 a[16:31], v[176:179], v[20:23], a[16:31]
    ds_read_b64_tr_b16 v[148:149], v209 offset:6208
    ds_read_b64_tr_b16 v[150:151], v209 offset:7744
    v_cvt_pk_bf16_f32 v24, v218, v219
    v_lshlrev_b32 v220, 16, v25
    v_and_b32 v221, 0xffff0000, v25
    v_fma_f32 v220, v220, v216, v217
    s_waitcnt lgkmcnt(8)
    v_mfma_f32_32x32x16_bf16 a[32:47], v[180:183], v[20:23], a[32:47]
    ds_read_b64_tr_b16 v[152:153], v208 offset:6272
    ds_read_b64_tr_b16 v[154:155], v208 offset:7808
    v_fma_f32 v221, v221, v216, v217
    v_cvt_pk_bf16_f32 v25, v220, v221
    v_lshlrev_b32 v218, 16, v26
    v_and_b32 v219, 0xffff0000, v26
    v_mfma_f32_32x32x16_bf16 a[48:63], v[184:187], v[20:23], a[48:63]
    ds_read_b64_tr_b16 v[156:157], v209 offset:6336
    ds_read_b64_tr_b16 v[158:159], v209 offset:7872
    v_fma_f32 v218, v218, v216, v217
    v_fma_f32 v219, v219, v216, v217
    v_cvt_pk_bf16_f32 v26, v218, v219
    v_lshlrev_b32 v220, 16, v27
    s_waitcnt lgkmcnt(8)
    v_mfma_f32_32x32x16_bf16 a[64:79], v[188:191], v[20:23], a[64:79]
    ds_read_b64_tr_b16 v[160:161], v208 offset:6400
    ds_read_b64_tr_b16 v[162:163], v208 offset:7936
    v_and_b32 v221, 0xffff0000, v27
    v_fma_f32 v220, v220, v216, v217
    v_fma_f32 v221, v221, v216, v217
    v_cvt_pk_bf16_f32 v27, v220, v221
    v_mfma_f32_32x32x16_bf16 a[80:95], v[192:195], v[20:23], a[80:95]
    ds_read_b64_tr_b16 v[164:165], v209 offset:6464
    ds_read_b64_tr_b16 v[166:167], v209 offset:8000
    s_waitcnt lgkmcnt(8)
    v_mfma_f32_32x32x16_bf16 a[0:15], v[144:147], v[24:27], a[0:15]
    ds_read_b64_tr_b16 v[172:173], v208 offset:9216
    ds_read_b64_tr_b16 v[174:175], v208 offset:10752
    v_lshlrev_b32 v218, 16, v28
    v_and_b32 v219, 0xffff0000, v28
    v_fma_f32 v218, v218, v216, v217
    v_fma_f32 v219, v219, v216, v217
    v_cvt_pk_bf16_f32 v28, v218, v219
    v_mfma_f32_32x32x16_bf16 a[16:31], v[148:151], v[24:27], a[16:31]
    ds_read_b64_tr_b16 v[176:177], v209 offset:9280
    ds_read_b64_tr_b16 v[178:179], v209 offset:10816
    v_lshlrev_b32 v220, 16, v29
    v_and_b32 v221, 0xffff0000, v29
    v_fma_f32 v220, v220, v216, v217
    v_fma_f32 v221, v221, v216, v217
    v_cvt_pk_bf16_f32 v29, v220, v221
    s_waitcnt lgkmcnt(8)
    v_mfma_f32_32x32x16_bf16 a[32:47], v[152:155], v[24:27], a[32:47]
    ds_read_b64_tr_b16 v[180:181], v208 offset:9344
    ds_read_b64_tr_b16 v[182:183], v208 offset:10880
    v_lshlrev_b32 v218, 16, v30
    v_and_b32 v219, 0xffff0000, v30
    v_fma_f32 v218, v218, v216, v217
    v_fma_f32 v219, v219, v216, v217
    v_cvt_pk_bf16_f32 v30, v218, v219
    v_mfma_f32_32x32x16_bf16 a[48:63], v[156:159], v[24:27], a[48:63]
    ds_read_b64_tr_b16 v[184:185], v209 offset:9408
    ds_read_b64_tr_b16 v[186:187], v209 offset:10944
    v_lshlrev_b32 v220, 16, v31
    v_and_b32 v221, 0xffff0000, v31
    v_fma_f32 v220, v220, v216, v217
    v_fma_f32 v221, v221, v216, v217
    v_cvt_pk_bf16_f32 v31, v220, v221
    s_waitcnt lgkmcnt(8)
    v_mfma_f32_32x32x16_bf16 a[64:79], v[160:163], v[24:27], a[64:79]
    ds_read_b64_tr_b16 v[188:189], v208 offset:9472
    ds_read_b64_tr_b16 v[190:191], v208 offset:11008
    v_lshlrev_b32 v218, 16, v112
    v_and_b32 v219, 0xffff0000, v112
    v_fma_f32 v218, v218, v216, v217
    v_fma_f32 v219, v219, v216, v217
    v_cvt_pk_bf16_f32 v112, v218, v219
    v_mfma_f32_32x32x16_bf16 a[80:95], v[164:167], v[24:27], a[80:95]
    ds_read_b64_tr_b16 v[192:193], v209 offset:9536
    ds_read_b64_tr_b16 v[194:195], v209 offset:11072
    v_lshlrev_b32 v220, 16, v113
    v_and_b32 v221, 0xffff0000, v113
    v_fma_f32 v220, v220, v216, v217
    v_fma_f32 v221, v221, v216, v217
    v_cvt_pk_bf16_f32 v113, v220, v221
    s_waitcnt vmcnt(6)
    s_barrier
    s_waitcnt lgkmcnt(8)
    v_mfma_f32_32x32x16_bf16 a[0:15], v[172:175], v[28:31], a[0:15]
    s_add_u32 m0, s30, 49152
    buffer_load_dwordx4 v200, s[16:19], s71 offen lds
    ds_read_b64_tr_b16 v[144:145], v210 offset:0
    ds_read_b64_tr_b16 v[146:147], v210 offset:1536
    v_lshlrev_b32 v218, 16, v32
    v_and_b32 v219, 0xffff0000, v32
    v_fma_f32 v218, v218, v216, v217
    v_fma_f32 v219, v219, v216, v217
    v_cvt_pk_bf16_f32 v32, v218, v219
    v_mfma_f32_32x32x16_bf16 a[16:31], v[176:179], v[28:31], a[16:31]
    ds_read_b64_tr_b16 v[148:149], v211 offset:64
    ds_read_b64_tr_b16 v[150:151], v211 offset:1600
    v_lshlrev_b32 v220, 16, v33
    v_and_b32 v221, 0xffff0000, v33
    v_fma_f32 v220, v220, v216, v217
    v_fma_f32 v221, v221, v216, v217
    v_cvt_pk_bf16_f32 v33, v220, v221
    s_waitcnt lgkmcnt(8)
    v_mfma_f32_32x32x16_bf16 a[32:47], v[180:183], v[28:31], a[32:47]
    ds_read_b64_tr_b16 v[152:153], v210 offset:128
    ds_read_b64_tr_b16 v[154:155], v210 offset:1664
    v_lshlrev_b32 v218, 16, v34
    v_and_b32 v219, 0xffff0000, v34
    v_fma_f32 v218, v218, v216, v217
    v_fma_f32 v219, v219, v216, v217
    v_cvt_pk_bf16_f32 v34, v218, v219
    v_mfma_f32_32x32x16_bf16 a[48:63], v[184:187], v[28:31], a[48:63]
    s_add_u32 m0, s30, 50176
    buffer_load_dwordx4 v201, s[16:19], s71 offen lds
    ds_read_b64_tr_b16 v[156:157], v211 offset:192
    ds_read_b64_tr_b16 v[158:159], v211 offset:1728
    v_lshlrev_b32 v220, 16, v35
    v_and_b32 v221, 0xffff0000, v35
    v_fma_f32 v220, v220, v216, v217
    v_fma_f32 v221, v221, v216, v217
    v_cvt_pk_bf16_f32 v35, v220, v221
    s_waitcnt lgkmcnt(8)
    v_mfma_f32_32x32x16_bf16 a[64:79], v[188:191], v[28:31], a[64:79]
    ds_read_b64_tr_b16 v[160:161], v210 offset:256
    ds_read_b64_tr_b16 v[162:163], v210 offset:1792
    v_lshlrev_b32 v218, 16, v114
    v_and_b32 v219, 0xffff0000, v114
    v_fma_f32 v218, v218, v216, v217
    v_fma_f32 v219, v219, v216, v217
    v_cvt_pk_bf16_f32 v114, v218, v219
    v_mfma_f32_32x32x16_bf16 a[80:95], v[192:195], v[28:31], a[80:95]
    ds_read_b64_tr_b16 v[164:165], v211 offset:320
    ds_read_b64_tr_b16 v[166:167], v211 offset:1856
    v_lshlrev_b32 v220, 16, v115
    v_and_b32 v221, 0xffff0000, v115
    v_fma_f32 v220, v220, v216, v217
    v_fma_f32 v221, v221, v216, v217
    v_cvt_pk_bf16_f32 v115, v220, v221
    s_waitcnt lgkmcnt(8)
    v_mfma_f32_32x32x16_bf16 a[0:15], v[144:147], v[32:35], a[0:15]
    s_add_u32 m0, s30, 51200
    buffer_load_dwordx4 v202, s[16:19], s71 offen lds
    ds_read_b64_tr_b16 v[172:173], v210 offset:3072
    ds_read_b64_tr_b16 v[174:175], v210 offset:4608
    v_lshlrev_b32 v218, 16, v36
    v_and_b32 v219, 0xffff0000, v36
    v_fma_f32 v218, v218, v216, v217
    v_fma_f32 v219, v219, v216, v217
    v_cvt_pk_bf16_f32 v36, v218, v219
    v_mfma_f32_32x32x16_bf16 a[16:31], v[148:151], v[32:35], a[16:31]
    ds_read_b64_tr_b16 v[176:177], v211 offset:3136
    ds_read_b64_tr_b16 v[178:179], v211 offset:4672
    v_lshlrev_b32 v220, 16, v37
    v_and_b32 v221, 0xffff0000, v37
    v_fma_f32 v220, v220, v216, v217
    v_fma_f32 v221, v221, v216, v217
    v_cvt_pk_bf16_f32 v37, v220, v221
    s_waitcnt lgkmcnt(8)
    v_mfma_f32_32x32x16_bf16 a[32:47], v[152:155], v[32:35], a[32:47]
    ds_read_b64_tr_b16 v[180:181], v210 offset:3200
    ds_read_b64_tr_b16 v[182:183], v210 offset:4736
    v_lshlrev_b32 v218, 16, v38
    v_and_b32 v219, 0xffff0000, v38
    v_fma_f32 v218, v218, v216, v217
    v_fma_f32 v219, v219, v216, v217
    v_cvt_pk_bf16_f32 v38, v218, v219
    v_mfma_f32_32x32x16_bf16 a[48:63], v[156:159], v[32:35], a[48:63]
    s_add_u32 m0, s30, 52224
    buffer_load_dwordx4 v203, s[16:19], s71 offen lds
    ds_read_b64_tr_b16 v[184:185], v211 offset:3264
    ds_read_b64_tr_b16 v[186:187], v211 offset:4800
    v_lshlrev_b32 v220, 16, v39
    v_and_b32 v221, 0xffff0000, v39
    v_fma_f32 v220, v220, v216, v217
    v_fma_f32 v221, v221, v216, v217
    v_cvt_pk_bf16_f32 v39, v220, v221
    s_waitcnt lgkmcnt(8)
    v_mfma_f32_32x32x16_bf16 a[64:79], v[160:163], v[32:35], a[64:79]
    ds_read_b64_tr_b16 v[188:189], v210 offset:3328
    ds_read_b64_tr_b16 v[190:191], v210 offset:4864
    v_lshlrev_b32 v218, 16, v116
    v_and_b32 v219, 0xffff0000, v116
    v_fma_f32 v218, v218, v216, v217
    v_fma_f32 v219, v219, v216, v217
    v_cvt_pk_bf16_f32 v116, v218, v219
    v_mfma_f32_32x32x16_bf16 a[80:95], v[164:167], v[32:35], a[80:95]
    ds_read_b64_tr_b16 v[192:193], v211 offset:3392
    ds_read_b64_tr_b16 v[194:195], v211 offset:4928
    v_lshlrev_b32 v220, 16, v117
    v_and_b32 v221, 0xffff0000, v117
    v_fma_f32 v220, v220, v216, v217
    v_fma_f32 v221, v221, v216, v217
    v_cvt_pk_bf16_f32 v117, v220, v221
    s_waitcnt lgkmcnt(8)
    v_mfma_f32_32x32x16_bf16 a[0:15], v[172:175], v[36:39], a[0:15]
    s_add_u32 m0, s30, 53248
    buffer_load_dwordx4 v204, s[16:19], s71 offen lds
    ds_read_b64_tr_b16 v[144:145], v210 offset:6144
    ds_read_b64_tr_b16 v[146:147], v210 offset:7680
    v_lshlrev_b32 v218, 16, v40
    v_and_b32 v219, 0xffff0000, v40
    v_fma_f32 v218, v218, v216, v217
    v_fma_f32 v219, v219, v216, v217
    v_cvt_pk_bf16_f32 v40, v218, v219
    v_mfma_f32_32x32x16_bf16 a[16:31], v[176:179], v[36:39], a[16:31]
    ds_read_b64_tr_b16 v[148:149], v211 offset:6208
    ds_read_b64_tr_b16 v[150:151], v211 offset:7744
    v_lshlrev_b32 v220, 16, v41
    v_and_b32 v221, 0xffff0000, v41
    v_fma_f32 v220, v220, v216, v217
    v_fma_f32 v221, v221, v216, v217
    v_cvt_pk_bf16_f32 v41, v220, v221
    s_waitcnt lgkmcnt(8)
    v_mfma_f32_32x32x16_bf16 a[32:47], v[180:183], v[36:39], a[32:47]
    ds_read_b64_tr_b16 v[152:153], v210 offset:6272
    ds_read_b64_tr_b16 v[154:155], v210 offset:7808
    v_lshlrev_b32 v218, 16, v42
    v_and_b32 v219, 0xffff0000, v42
    v_fma_f32 v218, v218, v216, v217
    v_fma_f32 v219, v219, v216, v217
    v_cvt_pk_bf16_f32 v42, v218, v219
    v_mfma_f32_32x32x16_bf16 a[48:63], v[184:187], v[36:39], a[48:63]
    s_add_u32 m0, s30, 54272
    buffer_load_dwordx4 v205, s[16:19], s71 offen lds
    ds_read_b64_tr_b16 v[156:157], v211 offset:6336
    ds_read_b64_tr_b16 v[158:159], v211 offset:7872
    v_lshlrev_b32 v220, 16, v43
    v_and_b32 v221, 0xffff0000, v43
    v_fma_f32 v220, v220, v216, v217
    v_fma_f32 v221, v221, v216, v217
    v_cvt_pk_bf16_f32 v43, v220, v221
    s_waitcnt lgkmcnt(8)
    v_mfma_f32_32x32x16_bf16 a[64:79], v[188:191], v[36:39], a[64:79]
    ds_read_b64_tr_b16 v[160:161], v210 offset:6400
    ds_read_b64_tr_b16 v[162:163], v210 offset:7936
    v_lshlrev_b32 v218, 16, v118
    v_and_b32 v219, 0xffff0000, v118
    v_fma_f32 v218, v218, v216, v217
    v_fma_f32 v219, v219, v216, v217
    v_cvt_pk_bf16_f32 v118, v218, v219
    v_mfma_f32_32x32x16_bf16 a[80:95], v[192:195], v[36:39], a[80:95]
    ds_read_b64_tr_b16 v[164:165], v211 offset:6464
    ds_read_b64_tr_b16 v[166:167], v211 offset:8000
    v_lshlrev_b32 v220, 16, v119
    v_and_b32 v221, 0xffff0000, v119
    v_fma_f32 v220, v220, v216, v217
    v_fma_f32 v221, v221, v216, v217
    v_cvt_pk_bf16_f32 v119, v220, v221
    s_waitcnt lgkmcnt(8)
    v_mfma_f32_32x32x16_bf16 a[0:15], v[144:147], v[40:43], a[0:15]
    ds_read_b64_tr_b16 v[172:173], v210 offset:9216
    ds_read_b64_tr_b16 v[174:175], v210 offset:10752
    v_lshlrev_b32 v218, 16, v44
    v_and_b32 v219, 0xffff0000, v44
    v_fma_f32 v218, v218, v216, v217
    v_fma_f32 v219, v219, v216, v217
    v_cvt_pk_bf16_f32 v44, v218, v219
    v_mfma_f32_32x32x16_bf16 a[16:31], v[148:151], v[40:43], a[16:31]
    ds_read_b64_tr_b16 v[176:177], v211 offset:9280
    ds_read_b64_tr_b16 v[178:179], v211 offset:10816
    v_lshlrev_b32 v220, 16, v45
    v_and_b32 v221, 0xffff0000, v45
    v_fma_f32 v220, v220, v216, v217
    v_fma_f32 v221, v221, v216, v217
    v_cvt_pk_bf16_f32 v45, v220, v221
    s_waitcnt lgkmcnt(8)
    v_mfma_f32_32x32x16_bf16 a[32:47], v[152:155], v[40:43], a[32:47]
    ds_read_b64_tr_b16 v[180:181], v210 offset:9344
    ds_read_b64_tr_b16 v[182:183], v210 offset:10880
    v_lshlrev_b32 v218, 16, v46
    v_and_b32 v219, 0xffff0000, v46
    v_fma_f32 v218, v218, v216, v217
    v_fma_f32 v219, v219, v216, v217
    v_cvt_pk_bf16_f32 v46, v218, v219
    v_mfma_f32_32x32x16_bf16 a[48:63], v[156:159], v[40:43], a[48:63]
    ds_read_b64_tr_b16 v[184:185], v211 offset:9408
    ds_read_b64_tr_b16 v[186:187], v211 offset:10944
    v_lshlrev_b32 v220, 16, v47
    v_and_b32 v221, 0xffff0000, v47
    v_fma_f32 v220, v220, v216, v217
    v_fma_f32 v221, v221, v216, v217
    v_cvt_pk_bf16_f32 v47, v220, v221
    s_waitcnt lgkmcnt(8)
    v_mfma_f32_32x32x16_bf16 a[64:79], v[160:163], v[40:43], a[64:79]
    ds_read_b64_tr_b16 v[188:189], v210 offset:9472
    ds_read_b64_tr_b16 v[190:191], v210 offset:11008
    v_lshlrev_b32 v218, 16, v120
    v_and_b32 v219, 0xffff0000, v120
    v_fma_f32 v218, v218, v216, v217
    v_fma_f32 v219, v219, v216, v217
    v_cvt_pk_bf16_f32 v120, v218, v219
    v_mfma_f32_32x32x16_bf16 a[80:95], v[164:167], v[40:43], a[80:95]
    ds_read_b64_tr_b16 v[192:193], v211 offset:9536
    ds_read_b64_tr_b16 v[194:195], v211 offset:11072
    v_lshlrev_b32 v220, 16, v121
    v_and_b32 v221, 0xffff0000, v121
    v_fma_f32 v220, v220, v216, v217
    v_fma_f32 v221, v221, v216, v217
    v_cvt_pk_bf16_f32 v121, v220, v221
    s_waitcnt vmcnt(6)
    s_barrier
    s_waitcnt lgkmcnt(8)
    v_mfma_f32_32x32x16_bf16 a[0:15], v[172:175], v[44:47], a[0:15]
    s_add_u32 m0, s30, 133120
    buffer_load_dwordx4 v200, s[16:19], s72 offen lds
    ds_read_b64_tr_b16 v[144:145], v212 offset:0
    ds_read_b64_tr_b16 v[146:147], v212 offset:1536
    v_lshlrev_b32 v218, 16, v48
    v_and_b32 v219, 0xffff0000, v48
    v_fma_f32 v218, v218, v216, v217
    v_fma_f32 v219, v219, v216, v217
    v_cvt_pk_bf16_f32 v48, v218, v219
    v_mfma_f32_32x32x16_bf16 a[16:31], v[176:179], v[44:47], a[16:31]
    ds_read_b64_tr_b16 v[148:149], v213 offset:64
    ds_read_b64_tr_b16 v[150:151], v213 offset:1600
    v_lshlrev_b32 v220, 16, v49
    v_and_b32 v221, 0xffff0000, v49
    v_fma_f32 v220, v220, v216, v217
    v_fma_f32 v221, v221, v216, v217
    v_cvt_pk_bf16_f32 v49, v220, v221
    s_waitcnt lgkmcnt(8)
    v_mfma_f32_32x32x16_bf16 a[32:47], v[180:183], v[44:47], a[32:47]
    ds_read_b64_tr_b16 v[152:153], v212 offset:128
    ds_read_b64_tr_b16 v[154:155], v212 offset:1664
    v_lshlrev_b32 v218, 16, v50
    v_and_b32 v219, 0xffff0000, v50
    v_fma_f32 v218, v218, v216, v217
    v_fma_f32 v219, v219, v216, v217
    v_cvt_pk_bf16_f32 v50, v218, v219
    v_mfma_f32_32x32x16_bf16 a[48:63], v[184:187], v[44:47], a[48:63]
    s_add_u32 m0, s30, 134144
    buffer_load_dwordx4 v201, s[16:19], s72 offen lds
    ds_read_b64_tr_b16 v[156:157], v213 offset:192
    ds_read_b64_tr_b16 v[158:159], v213 offset:1728
    v_lshlrev_b32 v220, 16, v51
    v_and_b32 v221, 0xffff0000, v51
    v_fma_f32 v220, v220, v216, v217
    v_fma_f32 v221, v221, v216, v217
    v_cvt_pk_bf16_f32 v51, v220, v221
    s_waitcnt lgkmcnt(8)
    v_mfma_f32_32x32x16_bf16 a[64:79], v[188:191], v[44:47], a[64:79]
    ds_read_b64_tr_b16 v[160:161], v212 offset:256
    ds_read_b64_tr_b16 v[162:163], v212 offset:1792
    v_lshlrev_b32 v218, 16, v122
    v_and_b32 v219, 0xffff0000, v122
    v_fma_f32 v218, v218, v216, v217
    v_fma_f32 v219, v219, v216, v217
    v_cvt_pk_bf16_f32 v122, v218, v219
    v_mfma_f32_32x32x16_bf16 a[80:95], v[192:195], v[44:47], a[80:95]
    ds_read_b64_tr_b16 v[164:165], v213 offset:320
    ds_read_b64_tr_b16 v[166:167], v213 offset:1856
    v_lshlrev_b32 v220, 16, v123
    v_and_b32 v221, 0xffff0000, v123
    v_fma_f32 v220, v220, v216, v217
    v_fma_f32 v221, v221, v216, v217
    v_cvt_pk_bf16_f32 v123, v220, v221
    s_waitcnt lgkmcnt(8)
    v_mfma_f32_32x32x16_bf16 a[0:15], v[144:147], v[48:51], a[0:15]
    s_add_u32 m0, s30, 135168
    buffer_load_dwordx4 v202, s[16:19], s72 offen lds
    ds_read_b64_tr_b16 v[172:173], v212 offset:3072
    ds_read_b64_tr_b16 v[174:175], v212 offset:4608
    v_lshlrev_b32 v218, 16, v52
    v_and_b32 v219, 0xffff0000, v52
    v_fma_f32 v218, v218, v216, v217
    v_fma_f32 v219, v219, v216, v217
    v_cvt_pk_bf16_f32 v52, v218, v219
    v_mfma_f32_32x32x16_bf16 a[16:31], v[148:151], v[48:51], a[16:31]
    ds_read_b64_tr_b16 v[176:177], v213 offset:3136
    ds_read_b64_tr_b16 v[178:179], v213 offset:4672
    v_lshlrev_b32 v220, 16, v53
    v_and_b32 v221, 0xffff0000, v53
    v_fma_f32 v220, v220, v216, v217
    v_fma_f32 v221, v221, v216, v217
    v_cvt_pk_bf16_f32 v53, v220, v221
    s_waitcnt lgkmcnt(8)
    v_mfma_f32_32x32x16_bf16 a[32:47], v[152:155], v[48:51], a[32:47]
    ds_read_b64_tr_b16 v[180:181], v212 offset:3200
    ds_read_b64_tr_b16 v[182:183], v212 offset:4736
    v_lshlrev_b32 v218, 16, v54
    v_and_b32 v219, 0xffff0000, v54
    v_fma_f32 v218, v218, v216, v217
    v_fma_f32 v219, v219, v216, v217
    v_cvt_pk_bf16_f32 v54, v218, v219
    v_mfma_f32_32x32x16_bf16 a[48:63], v[156:159], v[48:51], a[48:63]
    s_add_u32 m0, s30, 136192
    buffer_load_dwordx4 v203, s[16:19], s72 offen lds
    ds_read_b64_tr_b16 v[184:185], v213 offset:3264
    ds_read_b64_tr_b16 v[186:187], v213 offset:4800
    v_lshlrev_b32 v220, 16, v55
    v_and_b32 v221, 0xffff0000, v55
    v_fma_f32 v220, v220, v216, v217
    v_fma_f32 v221, v221, v216, v217
    v_cvt_pk_bf16_f32 v55, v220, v221
    s_waitcnt lgkmcnt(8)
    v_mfma_f32_32x32x16_bf16 a[64:79], v[160:163], v[48:51], a[64:79]
    ds_read_b64_tr_b16 v[188:189], v212 offset:3328
    ds_read_b64_tr_b16 v[190:191], v212 offset:4864
    v_lshlrev_b32 v218, 16, v124
    v_and_b32 v219, 0xffff0000, v124
    v_fma_f32 v218, v218, v216, v217
    v_fma_f32 v219, v219, v216, v217
    v_cvt_pk_bf16_f32 v124, v218, v219
    v_mfma_f32_32x32x16_bf16 a[80:95], v[164:167], v[48:51], a[80:95]
    ds_read_b64_tr_b16 v[192:193], v213 offset:3392
    ds_read_b64_tr_b16 v[194:195], v213 offset:4928
    v_lshlrev_b32 v220, 16, v125
    v_and_b32 v221, 0xffff0000, v125
    v_fma_f32 v220, v220, v216, v217
    v_fma_f32 v221, v221, v216, v217
    v_cvt_pk_bf16_f32 v125, v220, v221
    s_waitcnt lgkmcnt(8)
    v_mfma_f32_32x32x16_bf16 a[0:15], v[172:175], v[52:55], a[0:15]
    s_add_u32 m0, s30, 137216
    buffer_load_dwordx4 v204, s[16:19], s72 offen lds
    ds_read_b64_tr_b16 v[144:145], v212 offset:6144
    ds_read_b64_tr_b16 v[146:147], v212 offset:7680
    v_lshlrev_b32 v218, 16, v56
    v_and_b32 v219, 0xffff0000, v56
    v_fma_f32 v218, v218, v216, v217
    v_fma_f32 v219, v219, v216, v217
    v_cvt_pk_bf16_f32 v56, v218, v219
    v_mfma_f32_32x32x16_bf16 a[16:31], v[176:179], v[52:55], a[16:31]
    ds_read_b64_tr_b16 v[148:149], v213 offset:6208
    ds_read_b64_tr_b16 v[150:151], v213 offset:7744
    v_lshlrev_b32 v220, 16, v57
    v_and_b32 v221, 0xffff0000, v57
    v_fma_f32 v220, v220, v216, v217
    v_fma_f32 v221, v221, v216, v217
    v_cvt_pk_bf16_f32 v57, v220, v221
    s_waitcnt lgkmcnt(8)
    v_mfma_f32_32x32x16_bf16 a[32:47], v[180:183], v[52:55], a[32:47]
    ds_read_b64_tr_b16 v[152:153], v212 offset:6272
    ds_read_b64_tr_b16 v[154:155], v212 offset:7808
    v_lshlrev_b32 v218, 16, v58
    v_and_b32 v219, 0xffff0000, v58
    v_fma_f32 v218, v218, v216, v217
    v_fma_f32 v219, v219, v216, v217
    v_cvt_pk_bf16_f32 v58, v218, v219
    v_mfma_f32_32x32x16_bf16 a[48:63], v[184:187], v[52:55], a[48:63]
    s_add_u32 m0, s30, 138240
    buffer_load_dwordx4 v205, s[16:19], s72 offen lds
    ds_read_b64_tr_b16 v[156:157], v213 offset:6336
    ds_read_b64_tr_b16 v[158:159], v213 offset:7872
    v_lshlrev_b32 v220, 16, v59
    v_and_b32 v221, 0xffff0000, v59
    v_fma_f32 v220, v220, v216, v217
    v_fma_f32 v221, v221, v216, v217
    v_cvt_pk_bf16_f32 v59, v220, v221
    s_waitcnt lgkmcnt(8)
    v_mfma_f32_32x32x16_bf16 a[64:79], v[188:191], v[52:55], a[64:79]
    ds_read_b64_tr_b16 v[160:161], v212 offset:6400
    ds_read_b64_tr_b16 v[162:163], v212 offset:7936
    v_lshlrev_b32 v218, 16, v126
    v_and_b32 v219, 0xffff0000, v126
    v_fma_f32 v218, v218, v216, v217
    v_fma_f32 v219, v219, v216, v217
    v_cvt_pk_bf16_f32 v126, v218, v219
    v_mfma_f32_32x32x16_bf16 a[80:95], v[192:195], v[52:55], a[80:95]
    ds_read_b64_tr_b16 v[164:165], v213 offset:6464
    ds_read_b64_tr_b16 v[166:167], v213 offset:8000
    v_lshlrev_b32 v220, 16, v127
    v_and_b32 v221, 0xffff0000, v127
    v_fma_f32 v220, v220, v216, v217
    v_fma_f32 v221, v221, v216, v217
    v_cvt_pk_bf16_f32 v127, v220, v221
    s_waitcnt lgkmcnt(8)
    v_mfma_f32_32x32x16_bf16 a[0:15], v[144:147], v[56:59], a[0:15]
    ds_read_b64_tr_b16 v[172:173], v212 offset:9216
    ds_read_b64_tr_b16 v[174:175], v212 offset:10752
    v_lshlrev_b32 v218, 16, v60
    v_and_b32 v219, 0xffff0000, v60
    v_fma_f32 v218, v218, v216, v217
    v_fma_f32 v219, v219, v216, v217
    v_cvt_pk_bf16_f32 v60, v218, v219
    v_mfma_f32_32x32x16_bf16 a[16:31], v[148:151], v[56:59], a[16:31]
    ds_read_b64_tr_b16 v[176:177], v213 offset:9280
    ds_read_b64_tr_b16 v[178:179], v213 offset:10816
    v_lshlrev_b32 v220, 16, v61
    v_and_b32 v221, 0xffff0000, v61
    v_fma_f32 v220, v220, v216, v217
    v_fma_f32 v221, v221, v216, v217
    v_cvt_pk_bf16_f32 v61, v220, v221
    s_waitcnt lgkmcnt(8)
    v_mfma_f32_32x32x16_bf16 a[32:47], v[152:155], v[56:59], a[32:47]
    ds_read_b64_tr_b16 v[180:181], v212 offset:9344
    ds_read_b64_tr_b16 v[182:183], v212 offset:10880
    v_lshlrev_b32 v218, 16, v62
    v_and_b32 v219, 0xffff0000, v62
    v_fma_f32 v218, v218, v216, v217
    v_fma_f32 v219, v219, v216, v217
    v_cvt_pk_bf16_f32 v62, v218, v219
    v_mfma_f32_32x32x16_bf16 a[48:63], v[156:159], v[56:59], a[48:63]
    ds_read_b64_tr_b16 v[184:185], v213 offset:9408
    ds_read_b64_tr_b16 v[186:187], v213 offset:10944
    v_lshlrev_b32 v220, 16, v63
    v_and_b32 v221, 0xffff0000, v63
    v_fma_f32 v220, v220, v216, v217
    v_fma_f32 v221, v221, v216, v217
    v_cvt_pk_bf16_f32 v63, v220, v221
    s_waitcnt lgkmcnt(8)
    v_mfma_f32_32x32x16_bf16 a[64:79], v[160:163], v[56:59], a[64:79]
    ds_read_b64_tr_b16 v[188:189], v212 offset:9472
    ds_read_b64_tr_b16 v[190:191], v212 offset:11008
    v_lshlrev_b32 v218, 16, v128
    v_and_b32 v219, 0xffff0000, v128
    v_fma_f32 v218, v218, v216, v217
    v_fma_f32 v219, v219, v216, v217
    v_cvt_pk_bf16_f32 v128, v218, v219
    v_mfma_f32_32x32x16_bf16 a[80:95], v[164:167], v[56:59], a[80:95]
    ds_read_b64_tr_b16 v[192:193], v213 offset:9536
    ds_read_b64_tr_b16 v[194:195], v213 offset:11072
    v_lshlrev_b32 v220, 16, v129
    v_and_b32 v221, 0xffff0000, v129
    v_fma_f32 v220, v220, v216, v217
    v_fma_f32 v221, v221, v216, v217
    v_cvt_pk_bf16_f32 v129, v220, v221
    s_waitcnt vmcnt(6)
    s_barrier
    s_waitcnt lgkmcnt(8)
    v_mfma_f32_32x32x16_bf16 a[0:15], v[172:175], v[60:63], a[0:15]
    s_add_u32 m0, s30, 0
    buffer_load_dwordx4 v200, s[16:19], s73 offen lds
    ds_read_b64_tr_b16 v[144:145], v214 offset:0
    ds_read_b64_tr_b16 v[146:147], v214 offset:1536
    v_lshlrev_b32 v218, 16, v64
    v_and_b32 v219, 0xffff0000, v64
    v_fma_f32 v218, v218, v216, v217
    v_fma_f32 v219, v219, v216, v217
    v_cvt_pk_bf16_f32 v64, v218, v219
    v_mfma_f32_32x32x16_bf16 a[16:31], v[176:179], v[60:63], a[16:31]
    ds_read_b64_tr_b16 v[148:149], v215 offset:64
    ds_read_b64_tr_b16 v[150:151], v215 offset:1600
    v_lshlrev_b32 v220, 16, v65
    v_and_b32 v221, 0xffff0000, v65
    v_fma_f32 v220, v220, v216, v217
    v_fma_f32 v221, v221, v216, v217
    v_cvt_pk_bf16_f32 v65, v220, v221
    s_waitcnt lgkmcnt(8)
    v_mfma_f32_32x32x16_bf16 a[32:47], v[180:183], v[60:63], a[32:47]
    ds_read_b64_tr_b16 v[152:153], v214 offset:128
    ds_read_b64_tr_b16 v[154:155], v214 offset:1664
    v_lshlrev_b32 v218, 16, v66
    v_and_b32 v219, 0xffff0000, v66
    v_fma_f32 v218, v218, v216, v217
    v_fma_f32 v219, v219, v216, v217
    v_cvt_pk_bf16_f32 v66, v218, v219
    v_mfma_f32_32x32x16_bf16 a[48:63], v[184:187], v[60:63], a[48:63]
    s_add_u32 m0, s30, 1024
    buffer_load_dwordx4 v201, s[16:19], s73 offen lds
    ds_read_b64_tr_b16 v[156:157], v215 offset:192
    ds_read_b64_tr_b16 v[158:159], v215 offset:1728
    v_lshlrev_b32 v220, 16, v67
    v_and_b32 v221, 0xffff0000, v67
    v_fma_f32 v220, v220, v216, v217
    v_fma_f32 v221, v221, v216, v217
    v_cvt_pk_bf16_f32 v67, v220, v221
    s_waitcnt lgkmcnt(8)
    v_mfma_f32_32x32x16_bf16 a[64:79], v[188:191], v[60:63], a[64:79]
    ds_read_b64_tr_b16 v[160:161], v214 offset:256
    ds_read_b64_tr_b16 v[162:163], v214 offset:1792
    v_lshlrev_b32 v218, 16, v130
    v_and_b32 v219, 0xffff0000, v130
    v_fma_f32 v218, v218, v216, v217
    v_fma_f32 v219, v219, v216, v217
    v_cvt_pk_bf16_f32 v130, v218, v219
    v_mfma_f32_32x32x16_bf16 a[80:95], v[192:195], v[60:63], a[80:95]
    ds_read_b64_tr_b16 v[164:165], v215 offset:320
    ds_read_b64_tr_b16 v[166:167], v215 offset:1856
    v_lshlrev_b32 v220, 16, v131
    v_and_b32 v221, 0xffff0000, v131
    v_fma_f32 v220, v220, v216, v217
    v_fma_f32 v221, v221, v216, v217
    v_cvt_pk_bf16_f32 v131, v220, v221
    s_waitcnt lgkmcnt(8)
    v_mfma_f32_32x32x16_bf16 a[0:15], v[144:147], v[64:67], a[0:15]
    s_add_u32 m0, s30, 2048
    buffer_load_dwordx4 v202, s[16:19], s73 offen lds
    ds_read_b64_tr_b16 v[172:173], v214 offset:3072
    ds_read_b64_tr_b16 v[174:175], v214 offset:4608
    v_lshlrev_b32 v218, 16, v68
    v_and_b32 v219, 0xffff0000, v68
    v_fma_f32 v218, v218, v216, v217
    v_fma_f32 v219, v219, v216, v217
    v_cvt_pk_bf16_f32 v68, v218, v219
    v_mfma_f32_32x32x16_bf16 a[16:31], v[148:151], v[64:67], a[16:31]
    ds_read_b64_tr_b16 v[176:177], v215 offset:3136
    ds_read_b64_tr_b16 v[178:179], v215 offset:4672
    v_lshlrev_b32 v220, 16, v69
    v_and_b32 v221, 0xffff0000, v69
    v_fma_f32 v220, v220, v216, v217
    v_fma_f32 v221, v221, v216, v217
    v_cvt_pk_bf16_f32 v69, v220, v221
    s_waitcnt lgkmcnt(8)
    v_mfma_f32_32x32x16_bf16 a[32:47], v[152:155], v[64:67], a[32:47]
    ds_read_b64_tr_b16 v[180:181], v214 offset:3200
    ds_read_b64_tr_b16 v[182:183], v214 offset:4736
    v_lshlrev_b32 v218, 16, v70
    v_and_b32 v219, 0xffff0000, v70
    v_fma_f32 v218, v218, v216, v217
    v_fma_f32 v219, v219, v216, v217
    v_cvt_pk_bf16_f32 v70, v218, v219
    v_mfma_f32_32x32x16_bf16 a[48:63], v[156:159], v[64:67], a[48:63]
    s_add_u32 m0, s30, 3072
    buffer_load_dwordx4 v203, s[16:19], s73 offen lds
    ds_read_b64_tr_b16 v[184:185], v215 offset:3264
    ds_read_b64_tr_b16 v[186:187], v215 offset:4800
    v_lshlrev_b32 v220, 16, v71
    v_and_b32 v221, 0xffff0000, v71
    v_fma_f32 v220, v220, v216, v217
    v_fma_f32 v221, v221, v216, v217
    v_cvt_pk_bf16_f32 v71, v220, v221
    s_waitcnt lgkmcnt(8)
    v_mfma_f32_32x32x16_bf16 a[64:79], v[160:163], v[64:67], a[64:79]
    ds_read_b64_tr_b16 v[188:189], v214 offset:3328
    ds_read_b64_tr_b16 v[190:191], v214 offset:4864
    v_lshlrev_b32 v218, 16, v132
    v_and_b32 v219, 0xffff0000, v132
    v_fma_f32 v218, v218, v216, v217
    v_fma_f32 v219, v219, v216, v217
    v_cvt_pk_bf16_f32 v132, v218, v219
    v_mfma_f32_32x32x16_bf16 a[80:95], v[164:167], v[64:67], a[80:95]
    ds_read_b64_tr_b16 v[192:193], v215 offset:3392
    ds_read_b64_tr_b16 v[194:195], v215 offset:4928
    v_lshlrev_b32 v220, 16, v133
    v_and_b32 v221, 0xffff0000, v133
    v_fma_f32 v220, v220, v216, v217
    v_fma_f32 v221, v221, v216, v217
    v_cvt_pk_bf16_f32 v133, v220, v221
    s_waitcnt lgkmcnt(8)
    v_mfma_f32_32x32x16_bf16 a[0:15], v[172:175], v[68:71], a[0:15]
    s_add_u32 m0, s30, 4096
    buffer_load_dwordx4 v204, s[16:19], s73 offen lds
    ds_read_b64_tr_b16 v[144:145], v214 offset:6144
    ds_read_b64_tr_b16 v[146:147], v214 offset:7680
    v_lshlrev_b32 v218, 16, v72
    v_and_b32 v219, 0xffff0000, v72
    v_fma_f32 v218, v218, v216, v217
    v_fma_f32 v219, v219, v216, v217
    v_cvt_pk_bf16_f32 v72, v218, v219
    v_mfma_f32_32x32x16_bf16 a[16:31], v[176:179], v[68:71], a[16:31]
    ds_read_b64_tr_b16 v[148:149], v215 offset:6208
    ds_read_b64_tr_b16 v[150:151], v215 offset:7744
    v_lshlrev_b32 v220, 16, v73
    v_and_b32 v221, 0xffff0000, v73
    v_fma_f32 v220, v220, v216, v217
    v_fma_f32 v221, v221, v216, v217
    v_cvt_pk_bf16_f32 v73, v220, v221
    s_waitcnt lgkmcnt(8)
    v_mfma_f32_32x32x16_bf16 a[32:47], v[180:183], v[68:71], a[32:47]
    ds_read_b64_tr_b16 v[152:153], v214 offset:6272
    ds_read_b64_tr_b16 v[154:155], v214 offset:7808
    v_lshlrev_b32 v218, 16, v74
    v_and_b32 v219, 0xffff0000, v74
    v_fma_f32 v218, v218, v216, v217
    v_fma_f32 v219, v219, v216, v217
    v_cvt_pk_bf16_f32 v74, v218, v219
    v_mfma_f32_32x32x16_bf16 a[48:63], v[184:187], v[68:71], a[48:63]
    s_add_u32 m0, s30, 5120
    buffer_load_dwordx4 v205, s[16:19], s73 offen lds
    ds_read_b64_tr_b16 v[156:157], v215 offset:6336
    ds_read_b64_tr_b16 v[158:159], v215 offset:7872
    v_lshlrev_b32 v220, 16, v75
    v_and_b32 v221, 0xffff0000, v75
    v_fma_f32 v220, v220, v216, v217
    v_fma_f32 v221, v221, v216, v217
    v_cvt_pk_bf16_f32 v75, v220, v221
    s_waitcnt lgkmcnt(8)
    v_mfma_f32_32x32x16_bf16 a[64:79], v[188:191], v[68:71], a[64:79]
    ds_read_b64_tr_b16 v[160:161], v214 offset:6400
    ds_read_b64_tr_b16 v[162:163], v214 offset:7936
    v_lshlrev_b32 v218, 16, v134
    v_and_b32 v219, 0xffff0000, v134
    v_fma_f32 v218, v218, v216, v217
    v_fma_f32 v219, v219, v216, v217
    v_cvt_pk_bf16_f32 v134, v218, v219
    v_mfma_f32_32x32x16_bf16 a[80:95], v[192:195], v[68:71], a[80:95]
    ds_read_b64_tr_b16 v[164:165], v215 offset:6464
    ds_read_b64_tr_b16 v[166:167], v215 offset:8000
    v_lshlrev_b32 v220, 16, v135
    v_and_b32 v221, 0xffff0000, v135
    v_fma_f32 v220, v220, v216, v217
    v_fma_f32 v221, v221, v216, v217
    v_cvt_pk_bf16_f32 v135, v220, v221
    s_waitcnt lgkmcnt(8)
    v_mfma_f32_32x32x16_bf16 a[0:15], v[144:147], v[72:75], a[0:15]
    ds_read_b64_tr_b16 v[172:173], v214 offset:9216
    ds_read_b64_tr_b16 v[174:175], v214 offset:10752
    v_lshlrev_b32 v218, 16, v76
    v_and_b32 v219, 0xffff0000, v76
    v_fma_f32 v218, v218, v216, v217
    v_fma_f32 v219, v219, v216, v217
    v_cvt_pk_bf16_f32 v76, v218, v219
    v_mfma_f32_32x32x16_bf16 a[16:31], v[148:151], v[72:75], a[16:31]
    ds_read_b64_tr_b16 v[176:177], v215 offset:9280
    ds_read_b64_tr_b16 v[178:179], v215 offset:10816
    v_lshlrev_b32 v220, 16, v77
    v_and_b32 v221, 0xffff0000, v77
    v_fma_f32 v220, v220, v216, v217
    v_fma_f32 v221, v221, v216, v217
    v_cvt_pk_bf16_f32 v77, v220, v221
    s_waitcnt lgkmcnt(8)
    v_mfma_f32_32x32x16_bf16 a[32:47], v[152:155], v[72:75], a[32:47]
    ds_read_b64_tr_b16 v[180:181], v214 offset:9344
    ds_read_b64_tr_b16 v[182:183], v214 offset:10880
    v_lshlrev_b32 v218, 16, v78
    v_and_b32 v219, 0xffff0000, v78
    v_fma_f32 v218, v218, v216, v217
    v_fma_f32 v219, v219, v216, v217
    v_cvt_pk_bf16_f32 v78, v218, v219
    v_mfma_f32_32x32x16_bf16 a[48:63], v[156:159], v[72:75], a[48:63]
    ds_read_b64_tr_b16 v[184:185], v215 offset:9408
    ds_read_b64_tr_b16 v[186:187], v215 offset:10944
    v_lshlrev_b32 v220, 16, v79
    v_and_b32 v221, 0xffff0000, v79
    v_fma_f32 v220, v220, v216, v217
    v_fma_f32 v221, v221, v216, v217
    v_cvt_pk_bf16_f32 v79, v220, v221
    s_waitcnt lgkmcnt(8)
    v_mfma_f32_32x32x16_bf16 a[64:79], v[160:163], v[72:75], a[64:79]
    ds_read_b64_tr_b16 v[188:189], v214 offset:9472
    ds_read_b64_tr_b16 v[190:191], v214 offset:11008
    v_lshlrev_b32 v218, 16, v136
    v_and_b32 v219, 0xffff0000, v136
    v_fma_f32 v218, v218, v216, v217
    v_fma_f32 v219, v219, v216, v217
    v_cvt_pk_bf16_f32 v136, v218, v219
    v_mfma_f32_32x32x16_bf16 a[80:95], v[164:167], v[72:75], a[80:95]
    ds_read_b64_tr_b16 v[192:193], v215 offset:9536
    ds_read_b64_tr_b16 v[194:195], v215 offset:11072
    v_lshlrev_b32 v220, 16, v137
    v_and_b32 v221, 0xffff0000, v137
    v_fma_f32 v220, v220, v216, v217
    v_fma_f32 v221, v221, v216, v217
    v_cvt_pk_bf16_f32 v137, v220, v221
    s_waitcnt vmcnt(6)
    s_barrier
    s_waitcnt lgkmcnt(8)
    v_mfma_f32_32x32x16_bf16 a[0:15], v[172:175], v[76:79], a[0:15]
    s_add_u32 m0, s30, 24576
    buffer_load_dwordx4 v200, s[16:19], s74 offen lds
    ds_read_b64_tr_b16 v[144:145], v208 offset:0
    ds_read_b64_tr_b16 v[146:147], v208 offset:1536
    v_lshlrev_b32 v218, 16, v80
    v_and_b32 v219, 0xffff0000, v80
    v_fma_f32 v218, v218, v216, v217
    v_fma_f32 v219, v219, v216, v217
    v_cvt_pk_bf16_f32 v80, v218, v219
    v_mfma_f32_32x32x16_bf16 a[16:31], v[176:179], v[76:79], a[16:31]
    ds_read_b64_tr_b16 v[148:149], v209 offset:64
    ds_read_b64_tr_b16 v[150:151], v209 offset:1600
    v_lshlrev_b32 v220, 16, v81
    v_and_b32 v221, 0xffff0000, v81
    v_fma_f32 v220, v220, v216, v217
    v_fma_f32 v221, v221, v216, v217
    v_cvt_pk_bf16_f32 v81, v220, v221
    s_waitcnt lgkmcnt(8)
    v_mfma_f32_32x32x16_bf16 a[32:47], v[180:183], v[76:79], a[32:47]
    s_add_u32 m0, s30, 25600
    buffer_load_dwordx4 v201, s[16:19], s74 offen lds
    ds_read_b64_tr_b16 v[152:153], v208 offset:128
    ds_read_b64_tr_b16 v[154:155], v208 offset:1664
    v_lshlrev_b32 v218, 16, v82
    v_and_b32 v219, 0xffff0000, v82
    v_fma_f32 v218, v218, v216, v217
    v_fma_f32 v219, v219, v216, v217
    v_cvt_pk_bf16_f32 v82, v218, v219
    v_mfma_f32_32x32x16_bf16 a[48:63], v[184:187], v[76:79], a[48:63]
    ds_read_b64_tr_b16 v[156:157], v209 offset:192
    ds_read_b64_tr_b16 v[158:159], v209 offset:1728
    v_lshlrev_b32 v220, 16, v83
    v_and_b32 v221, 0xffff0000, v83
    v_fma_f32 v220, v220, v216, v217
    v_fma_f32 v221, v221, v216, v217
    v_cvt_pk_bf16_f32 v83, v220, v221
    s_waitcnt lgkmcnt(8)
    v_mfma_f32_32x32x16_bf16 a[64:79], v[188:191], v[76:79], a[64:79]
    s_add_u32 m0, s30, 26624
    buffer_load_dwordx4 v202, s[16:19], s74 offen lds
    ds_read_b64_tr_b16 v[160:161], v208 offset:256
    ds_read_b64_tr_b16 v[162:163], v208 offset:1792
    v_lshlrev_b32 v218, 16, v138
    v_and_b32 v219, 0xffff0000, v138
    v_fma_f32 v218, v218, v216, v217
    v_fma_f32 v219, v219, v216, v217
    v_cvt_pk_bf16_f32 v138, v218, v219
    v_mfma_f32_32x32x16_bf16 a[80:95], v[192:195], v[76:79], a[80:95]
    ds_read_b64_tr_b16 v[164:165], v209 offset:320
    ds_read_b64_tr_b16 v[166:167], v209 offset:1856
    v_lshlrev_b32 v220, 16, v139
    v_and_b32 v221, 0xffff0000, v139
    v_fma_f32 v220, v220, v216, v217
    v_fma_f32 v221, v221, v216, v217
    v_cvt_pk_bf16_f32 v139, v220, v221
    s_waitcnt lgkmcnt(8)
    v_mfma_f32_32x32x16_bf16 a[0:15], v[144:147], v[80:83], a[0:15]
    s_add_u32 m0, s30, 27648
    buffer_load_dwordx4 v203, s[16:19], s74 offen lds
    ds_read_b64_tr_b16 v[172:173], v208 offset:3072
    ds_read_b64_tr_b16 v[174:175], v208 offset:4608
    v_lshlrev_b32 v218, 16, v84
    v_and_b32 v219, 0xffff0000, v84
    v_fma_f32 v218, v218, v216, v217
    v_fma_f32 v219, v219, v216, v217
    v_cvt_pk_bf16_f32 v84, v218, v219
    v_mfma_f32_32x32x16_bf16 a[16:31], v[148:151], v[80:83], a[16:31]
    ds_read_b64_tr_b16 v[176:177], v209 offset:3136
    ds_read_b64_tr_b16 v[178:179], v209 offset:4672
    v_lshlrev_b32 v220, 16, v85
    v_and_b32 v221, 0xffff0000, v85
    v_fma_f32 v220, v220, v216, v217
    v_fma_f32 v221, v221, v216, v217
    v_cvt_pk_bf16_f32 v85, v220, v221
    s_waitcnt lgkmcnt(8)
    v_mfma_f32_32x32x16_bf16 a[32:47], v[152:155], v[80:83], a[32:47]
    s_add_u32 m0, s30, 28672
    buffer_load_dwordx4 v204, s[16:19], s74 offen lds
    ds_read_b64_tr_b16 v[180:181], v208 offset:3200
    ds_read_b64_tr_b16 v[182:183], v208 offset:4736
    v_lshlrev_b32 v218, 16, v86
    v_and_b32 v219, 0xffff0000, v86
    v_fma_f32 v218, v218, v216, v217
    v_fma_f32 v219, v219, v216, v217
    v_cvt_pk_bf16_f32 v86, v218, v219
    v_mfma_f32_32x32x16_bf16 a[48:63], v[156:159], v[80:83], a[48:63]
    ds_read_b64_tr_b16 v[184:185], v209 offset:3264
    ds_read_b64_tr_b16 v[186:187], v209 offset:4800
    v_lshlrev_b32 v220, 16, v87
    v_and_b32 v221, 0xffff0000, v87
    v_fma_f32 v220, v220, v216, v217
    v_fma_f32 v221, v221, v216, v217
    v_cvt_pk_bf16_f32 v87, v220, v221
    s_waitcnt lgkmcnt(8)
    v_mfma_f32_32x32x16_bf16 a[64:79], v[160:163], v[80:83], a[64:79]
    s_add_u32 m0, s30, 29696
    buffer_load_dwordx4 v205, s[16:19], s74 offen lds
    ds_read_b64_tr_b16 v[188:189], v208 offset:3328
    ds_read_b64_tr_b16 v[190:191], v208 offset:4864
    v_lshlrev_b32 v218, 16, v140
    v_and_b32 v219, 0xffff0000, v140
    v_fma_f32 v218, v218, v216, v217
    v_fma_f32 v219, v219, v216, v217
    v_cvt_pk_bf16_f32 v140, v218, v219
    v_mfma_f32_32x32x16_bf16 a[80:95], v[164:167], v[80:83], a[80:95]
    ds_read_b64_tr_b16 v[192:193], v209 offset:3392
    ds_read_b64_tr_b16 v[194:195], v209 offset:4928
    v_lshlrev_b32 v220, 16, v141
    v_and_b32 v221, 0xffff0000, v141
    v_fma_f32 v220, v220, v216, v217
    v_fma_f32 v221, v221, v216, v217
    v_cvt_pk_bf16_f32 v141, v220, v221
    s_waitcnt lgkmcnt(8)
    v_mfma_f32_32x32x16_bf16 a[0:15], v[172:175], v[84:87], a[0:15]
    s_add_u32 m0, s30, 49152
    buffer_load_dwordx4 v200, s[16:19], s75 offen lds
    ds_read_b64_tr_b16 v[144:145], v208 offset:6144
    ds_read_b64_tr_b16 v[146:147], v208 offset:7680
    v_lshlrev_b32 v218, 16, v88
    v_and_b32 v219, 0xffff0000, v88
    v_fma_f32 v218, v218, v216, v217
    v_fma_f32 v219, v219, v216, v217
    v_cvt_pk_bf16_f32 v88, v218, v219
    v_mfma_f32_32x32x16_bf16 a[16:31], v[176:179], v[84:87], a[16:31]
    ds_read_b64_tr_b16 v[148:149], v209 offset:6208
    ds_read_b64_tr_b16 v[150:151], v209 offset:7744
    v_lshlrev_b32 v220, 16, v89
    v_and_b32 v221, 0xffff0000, v89
    v_fma_f32 v220, v220, v216, v217
    v_fma_f32 v221, v221, v216, v217
    v_cvt_pk_bf16_f32 v89, v220, v221
    s_waitcnt lgkmcnt(8)
    v_mfma_f32_32x32x16_bf16 a[32:47], v[180:183], v[84:87], a[32:47]
    s_add_u32 m0, s30, 50176
    buffer_load_dwordx4 v201, s[16:19], s75 offen lds
    ds_read_b64_tr_b16 v[152:153], v208 offset:6272
    ds_read_b64_tr_b16 v[154:155], v208 offset:7808
    v_lshlrev_b32 v218, 16, v90
    v_and_b32 v219, 0xffff0000, v90
    v_fma_f32 v218, v218, v216, v217
    v_fma_f32 v219, v219, v216, v217
    v_cvt_pk_bf16_f32 v90, v218, v219
    v_mfma_f32_32x32x16_bf16 a[48:63], v[184:187], v[84:87], a[48:63]
    ds_read_b64_tr_b16 v[156:157], v209 offset:6336
    ds_read_b64_tr_b16 v[158:159], v209 offset:7872
    v_lshlrev_b32 v220, 16, v91
    v_and_b32 v221, 0xffff0000, v91
    v_fma_f32 v220, v220, v216, v217
    v_fma_f32 v221, v221, v216, v217
    v_cvt_pk_bf16_f32 v91, v220, v221
    s_waitcnt lgkmcnt(8)
    v_mfma_f32_32x32x16_bf16 a[64:79], v[188:191], v[84:87], a[64:79]
    s_add_u32 m0, s30, 51200
    buffer_load_dwordx4 v202, s[16:19], s75 offen lds
    ds_read_b64_tr_b16 v[160:161], v208 offset:6400
    ds_read_b64_tr_b16 v[162:163], v208 offset:7936
    v_lshlrev_b32 v218, 16, v142
    v_and_b32 v219, 0xffff0000, v142
    v_fma_f32 v218, v218, v216, v217
    v_fma_f32 v219, v219, v216, v217
    v_cvt_pk_bf16_f32 v142, v218, v219
    v_mfma_f32_32x32x16_bf16 a[80:95], v[192:195], v[84:87], a[80:95]
    ds_read_b64_tr_b16 v[164:165], v209 offset:6464
    ds_read_b64_tr_b16 v[166:167], v209 offset:8000
    v_lshlrev_b32 v220, 16, v143
    v_and_b32 v221, 0xffff0000, v143
    v_fma_f32 v220, v220, v216, v217
    v_fma_f32 v221, v221, v216, v217
    v_cvt_pk_bf16_f32 v143, v220, v221
    s_waitcnt lgkmcnt(8)
    v_mfma_f32_32x32x16_bf16 a[0:15], v[144:147], v[88:91], a[0:15]
    s_add_u32 m0, s30, 52224
    buffer_load_dwordx4 v203, s[16:19], s75 offen lds
    ds_read_b64_tr_b16 v[172:173], v208 offset:9216
    ds_read_b64_tr_b16 v[174:175], v208 offset:10752
    v_lshlrev_b32 v218, 16, v92
    v_and_b32 v219, 0xffff0000, v92
    v_fma_f32 v218, v218, v216, v217
    v_fma_f32 v219, v219, v216, v217
    v_mfma_f32_32x32x16_bf16 a[16:31], v[148:151], v[88:91], a[16:31]
    ds_read_b64_tr_b16 v[176:177], v209 offset:9280
    ds_read_b64_tr_b16 v[178:179], v209 offset:10816
    v_cvt_pk_bf16_f32 v92, v218, v219
    v_lshlrev_b32 v220, 16, v93
    v_and_b32 v221, 0xffff0000, v93
    v_fma_f32 v220, v220, v216, v217
    s_waitcnt lgkmcnt(8)
    v_mfma_f32_32x32x16_bf16 a[32:47], v[152:155], v[88:91], a[32:47]
    s_add_u32 m0, s30, 53248
    buffer_load_dwordx4 v204, s[16:19], s75 offen lds
    ds_read_b64_tr_b16 v[180:181], v208 offset:9344
    ds_read_b64_tr_b16 v[182:183], v208 offset:10880
    v_fma_f32 v221, v221, v216, v217
    v_cvt_pk_bf16_f32 v93, v220, v221
    v_lshlrev_b32 v218, 16, v94
    v_and_b32 v219, 0xffff0000, v94
    v_mfma_f32_32x32x16_bf16 a[48:63], v[156:159], v[88:91], a[48:63]
    ds_read_b64_tr_b16 v[184:185], v209 offset:9408
    ds_read_b64_tr_b16 v[186:187], v209 offset:10944
    v_fma_f32 v218, v218, v216, v217
    v_fma_f32 v219, v219, v216, v217
    v_cvt_pk_bf16_f32 v94, v218, v219
    v_lshlrev_b32 v220, 16, v95
    s_waitcnt lgkmcnt(8)
    v_mfma_f32_32x32x16_bf16 a[64:79], v[160:163], v[88:91], a[64:79]
    s_add_u32 m0, s30, 54272
    buffer_load_dwordx4 v205, s[16:19], s75 offen lds
    ds_read_b64_tr_b16 v[188:189], v208 offset:9472
    ds_read_b64_tr_b16 v[190:191], v208 offset:11008
    v_and_b32 v221, 0xffff0000, v95
    v_fma_f32 v220, v220, v216, v217
    v_fma_f32 v221, v221, v216, v217
    v_cvt_pk_bf16_f32 v95, v220, v221
    v_mfma_f32_32x32x16_bf16 a[80:95], v[164:167], v[88:91], a[80:95]
    ds_read_b64_tr_b16 v[192:193], v209 offset:9536
    ds_read_b64_tr_b16 v[194:195], v209 offset:11072
    s_waitcnt vmcnt(12)
    s_barrier
    s_waitcnt lgkmcnt(8)
    v_mfma_f32_32x32x16_bf16 a[0:15], v[172:175], v[92:95], a[0:15]
    ds_read_b64_tr_b16 v[144:145], v210 offset:0
    ds_read_b64_tr_b16 v[146:147], v210 offset:1536
    v_lshlrev_b32 v218, 16, v96
    v_and_b32 v219, 0xffff0000, v96
    v_fma_f32 v218, v218, v216, v217
    v_fma_f32 v219, v219, v216, v217
    v_mfma_f32_32x32x16_bf16 a[16:31], v[176:179], v[92:95], a[16:31]
    ds_read_b64_tr_b16 v[148:149], v211 offset:64
    ds_read_b64_tr_b16 v[150:151], v211 offset:1600
    v_cvt_pk_bf16_f32 v96, v218, v219
    v_lshlrev_b32 v220, 16, v97
    v_and_b32 v221, 0xffff0000, v97
    v_fma_f32 v220, v220, v216, v217
    s_waitcnt lgkmcnt(8)
    v_mfma_f32_32x32x16_bf16 a[32:47], v[180:183], v[92:95], a[32:47]
    ds_read_b64_tr_b16 v[152:153], v210 offset:128
    ds_read_b64_tr_b16 v[154:155], v210 offset:1664
    v_fma_f32 v221, v221, v216, v217
    v_cvt_pk_bf16_f32 v97, v220, v221
    v_lshlrev_b32 v218, 16, v98
    v_and_b32 v219, 0xffff0000, v98
    v_mfma_f32_32x32x16_bf16 a[48:63], v[184:187], v[92:95], a[48:63]
    ds_read_b64_tr_b16 v[156:157], v211 offset:192
    ds_read_b64_tr_b16 v[158:159], v211 offset:1728
    v_fma_f32 v218, v218, v216, v217
    v_fma_f32 v219, v219, v216, v217
    v_cvt_pk_bf16_f32 v98, v218, v219
    v_lshlrev_b32 v220, 16, v99
    s_waitcnt lgkmcnt(8)
    v_mfma_f32_32x32x16_bf16 a[64:79], v[188:191], v[92:95], a[64:79]
    ds_read_b64_tr_b16 v[160:161], v210 offset:256
    ds_read_b64_tr_b16 v[162:163], v210 offset:1792
    v_and_b32 v221, 0xffff0000, v99
    v_fma_f32 v220, v220, v216, v217
    v_fma_f32 v221, v221, v216, v217
    v_cvt_pk_bf16_f32 v99, v220, v221
    v_mfma_f32_32x32x16_bf16 a[80:95], v[192:195], v[92:95], a[80:95]
    ds_read_b64_tr_b16 v[164:165], v211 offset:320
    ds_read_b64_tr_b16 v[166:167], v211 offset:1856
    s_waitcnt lgkmcnt(8)
    v_mfma_f32_32x32x16_bf16 a[0:15], v[144:147], v[96:99], a[0:15]
    ds_read_b64_tr_b16 v[172:173], v210 offset:3072
    ds_read_b64_tr_b16 v[174:175], v210 offset:4608
    v_lshlrev_b32 v218, 16, v100
    v_and_b32 v219, 0xffff0000, v100
    v_fma_f32 v218, v218, v216, v217
    v_fma_f32 v219, v219, v216, v217
    v_mfma_f32_32x32x16_bf16 a[16:31], v[148:151], v[96:99], a[16:31]
    ds_read_b64_tr_b16 v[176:177], v211 offset:3136
    ds_read_b64_tr_b16 v[178:179], v211 offset:4672
    v_cvt_pk_bf16_f32 v100, v218, v219
    v_lshlrev_b32 v220, 16, v101
    v_and_b32 v221, 0xffff0000, v101
    v_fma_f32 v220, v220, v216, v217
    s_waitcnt lgkmcnt(8)
    v_mfma_f32_32x32x16_bf16 a[32:47], v[152:155], v[96:99], a[32:47]
    ds_read_b64_tr_b16 v[180:181], v210 offset:3200
    ds_read_b64_tr_b16 v[182:183], v210 offset:4736
    v_fma_f32 v221, v221, v216, v217
    v_cvt_pk_bf16_f32 v101, v220, v221
    v_lshlrev_b32 v218, 16, v102
    v_and_b32 v219, 0xffff0000, v102
    v_mfma_f32_32x32x16_bf16 a[48:63], v[156:159], v[96:99], a[48:63]
    ds_read_b64_tr_b16 v[184:185], v211 offset:3264
    ds_read_b64_tr_b16 v[186:187], v211 offset:4800
    v_fma_f32 v218, v218, v216, v217
    v_fma_f32 v219, v219, v216, v217
    v_cvt_pk_bf16_f32 v102, v218, v219
    v_lshlrev_b32 v220, 16, v103
    s_waitcnt lgkmcnt(8)
    v_mfma_f32_32x32x16_bf16 a[64:79], v[160:163], v[96:99], a[64:79]
    ds_read_b64_tr_b16 v[188:189], v210 offset:3328
    ds_read_b64_tr_b16 v[190:191], v210 offset:4864
    v_and_b32 v221, 0xffff0000, v103
    v_fma_f32 v220, v220, v216, v217
    v_fma_f32 v221, v221, v216, v217
    v_cvt_pk_bf16_f32 v103, v220, v221
    v_mfma_f32_32x32x16_bf16 a[80:95], v[164:167], v[96:99], a[80:95]
    ds_read_b64_tr_b16 v[192:193], v211 offset:3392
    ds_read_b64_tr_b16 v[194:195], v211 offset:4928
    s_waitcnt lgkmcnt(8)
    v_mfma_f32_32x32x16_bf16 a[0:15], v[172:175], v[100:103], a[0:15]
    ds_read_b64_tr_b16 v[144:145], v210 offset:6144
    ds_read_b64_tr_b16 v[146:147], v210 offset:7680
    v_lshlrev_b32 v218, 16, v104
    v_and_b32 v219, 0xffff0000, v104
    v_fma_f32 v218, v218, v216, v217
    v_fma_f32 v219, v219, v216, v217
    v_mfma_f32_32x32x16_bf16 a[16:31], v[176:179], v[100:103], a[16:31]
    ds_read_b64_tr_b16 v[148:149], v211 offset:6208
    ds_read_b64_tr_b16 v[150:151], v211 offset:7744
    v_cvt_pk_bf16_f32 v104, v218, v219
    v_lshlrev_b32 v220, 16, v105
    v_and_b32 v221, 0xffff0000, v105
    v_fma_f32 v220, v220, v216, v217
    s_waitcnt lgkmcnt(8)
    v_mfma_f32_32x32x16_bf16 a[32:47], v[180:183], v[100:103], a[32:47]
    ds_read_b64_tr_b16 v[152:153], v210 offset:6272
    ds_read_b64_tr_b16 v[154:155], v210 offset:7808
    v_fma_f32 v221, v221, v216, v217
    v_cvt_pk_bf16_f32 v105, v220, v221
    v_lshlrev_b32 v218, 16, v106
    v_and_b32 v219, 0xffff0000, v106
    v_mfma_f32_32x32x16_bf16 a[48:63], v[184:187], v[100:103], a[48:63]
    ds_read_b64_tr_b16 v[156:157], v211 offset:6336
    ds_read_b64_tr_b16 v[158:159], v211 offset:7872
    v_fma_f32 v218, v218, v216, v217
    v_fma_f32 v219, v219, v216, v217
    v_cvt_pk_bf16_f32 v106, v218, v219
    v_lshlrev_b32 v220, 16, v107
    s_waitcnt lgkmcnt(8)
    v_mfma_f32_32x32x16_bf16 a[64:79], v[188:191], v[100:103], a[64:79]
    ds_read_b64_tr_b16 v[160:161], v210 offset:6400
    ds_read_b64_tr_b16 v[162:163], v210 offset:7936
    v_and_b32 v221, 0xffff0000, v107
    v_fma_f32 v220, v220, v216, v217
    v_fma_f32 v221, v221, v216, v217
    v_cvt_pk_bf16_f32 v107, v220, v221
    v_mfma_f32_32x32x16_bf16 a[80:95], v[192:195], v[100:103], a[80:95]
    ds_read_b64_tr_b16 v[164:165], v211 offset:6464
    ds_read_b64_tr_b16 v[166:167], v211 offset:8000
    s_waitcnt lgkmcnt(8)
    v_mfma_f32_32x32x16_bf16 a[0:15], v[144:147], v[104:107], a[0:15]
    ds_read_b64_tr_b16 v[172:173], v210 offset:9216
    ds_read_b64_tr_b16 v[174:175], v210 offset:10752
    v_lshlrev_b32 v218, 16, v108
    v_and_b32 v219, 0xffff0000, v108
    v_fma_f32 v218, v218, v216, v217
    v_fma_f32 v219, v219, v216, v217
    v_mfma_f32_32x32x16_bf16 a[16:31], v[148:151], v[104:107], a[16:31]
    ds_read_b64_tr_b16 v[176:177], v211 offset:9280
    ds_read_b64_tr_b16 v[178:179], v211 offset:10816
    v_cvt_pk_bf16_f32 v108, v218, v219
    v_lshlrev_b32 v220, 16, v109
    v_and_b32 v221, 0xffff0000, v109
    v_fma_f32 v220, v220, v216, v217
    s_waitcnt lgkmcnt(8)
    v_mfma_f32_32x32x16_bf16 a[32:47], v[152:155], v[104:107], a[32:47]
    ds_read_b64_tr_b16 v[180:181], v210 offset:9344
    ds_read_b64_tr_b16 v[182:183], v210 offset:10880
    v_fma_f32 v221, v221, v216, v217
    v_cvt_pk_bf16_f32 v109, v220, v221
    v_lshlrev_b32 v218, 16, v110
    v_and_b32 v219, 0xffff0000, v110
    v_mfma_f32_32x32x16_bf16 a[48:63], v[156:159], v[104:107], a[48:63]
    ds_read_b64_tr_b16 v[184:185], v211 offset:9408
    ds_read_b64_tr_b16 v[186:187], v211 offset:10944
    v_fma_f32 v218, v218, v216, v217
    v_fma_f32 v219, v219, v216, v217
    v_cvt_pk_bf16_f32 v110, v218, v219
    v_lshlrev_b32 v220, 16, v111
    s_waitcnt lgkmcnt(8)
    v_mfma_f32_32x32x16_bf16 a[64:79], v[160:163], v[104:107], a[64:79]
    ds_read_b64_tr_b16 v[188:189], v210 offset:9472
    ds_read_b64_tr_b16 v[190:191], v210 offset:11008
    v_and_b32 v221, 0xffff0000, v111
    v_fma_f32 v220, v220, v216, v217
    v_fma_f32 v221, v221, v216, v217
    v_cvt_pk_bf16_f32 v111, v220, v221
    v_mfma_f32_32x32x16_bf16 a[80:95], v[164:167], v[104:107], a[80:95]
    ds_read_b64_tr_b16 v[192:193], v211 offset:9536
    ds_read_b64_tr_b16 v[194:195], v211 offset:11072
    s_waitcnt vmcnt(0)
    s_barrier
    s_waitcnt lgkmcnt(0)
    v_mfma_f32_32x32x16_bf16 a[0:15], v[172:175], v[108:111], a[0:15]
    ds_read_b64_tr_b16 v[16:17], v212 offset:0
    ds_read_b64_tr_b16 v[18:19], v212 offset:1536
    ds_read_b64_tr_b16 v[20:21], v212 offset:3072
    ds_read_b64_tr_b16 v[22:23], v212 offset:4608
    v_mfma_f32_32x32x16_bf16 a[16:31], v[176:179], v[108:111], a[16:31]
    ds_read_b64_tr_b16 v[24:25], v212 offset:6144
    ds_read_b64_tr_b16 v[26:27], v212 offset:7680
    ds_read_b64_tr_b16 v[28:29], v212 offset:9216
    ds_read_b64_tr_b16 v[30:31], v212 offset:10752
    v_mfma_f32_32x32x16_bf16 a[32:47], v[180:183], v[108:111], a[32:47]
    ds_read_b64_tr_b16 v[32:33], v214 offset:0
    ds_read_b64_tr_b16 v[34:35], v214 offset:1536
    ds_read_b64_tr_b16 v[36:37], v214 offset:3072
    ds_read_b64_tr_b16 v[38:39], v214 offset:4608
    v_mfma_f32_32x32x16_bf16 a[48:63], v[184:187], v[108:111], a[48:63]
    ds_read_b64_tr_b16 v[40:41], v214 offset:6144
    ds_read_b64_tr_b16 v[42:43], v214 offset:7680
    ds_read_b64_tr_b16 v[44:45], v214 offset:9216
    ds_read_b64_tr_b16 v[46:47], v214 offset:10752
    v_mfma_f32_32x32x16_bf16 a[64:79], v[188:191], v[108:111], a[64:79]
    v_mfma_f32_32x32x16_bf16 a[80:95], v[192:195], v[108:111], a[80:95]
    v_lshlrev_b32 v222, 4, v2
    v_lshl_add_u32 v222, v3, 15, v222
    s_mul_i32 s28, s25, 786432
    s_waitcnt lgkmcnt(0)
    v_mfma_f32_32x32x16_bf16 a[0:15], v[16:19], v[112:115], a[0:15]
    ds_read_b64_tr_b16 v[48:49], v213 offset:64
    ds_read_b64_tr_b16 v[50:51], v213 offset:1600
    ds_read_b64_tr_b16 v[52:53], v213 offset:3136
    ds_read_b64_tr_b16 v[54:55], v213 offset:4672
    ds_read_b64_tr_b16 v[56:57], v213 offset:6208
    ds_read_b64_tr_b16 v[58:59], v213 offset:7744
    ds_read_b64_tr_b16 v[60:61], v213 offset:9280
    ds_read_b64_tr_b16 v[62:63], v213 offset:10816
    v_mfma_f32_32x32x16_bf16 a[0:15], v[20:23], v[116:119], a[0:15]
    ds_read_b64_tr_b16 v[64:65], v215 offset:64
    ds_read_b64_tr_b16 v[66:67], v215 offset:1600
    ds_read_b64_tr_b16 v[68:69], v215 offset:3136
    ds_read_b64_tr_b16 v[70:71], v215 offset:4672
    ds_read_b64_tr_b16 v[72:73], v215 offset:6208
    ds_read_b64_tr_b16 v[74:75], v215 offset:7744
    ds_read_b64_tr_b16 v[76:77], v215 offset:9280
    ds_read_b64_tr_b16 v[78:79], v215 offset:10816
    v_mfma_f32_32x32x16_bf16 a[0:15], v[24:27], v[120:123], a[0:15]
    v_mfma_f32_32x32x16_bf16 a[0:15], v[28:31], v[124:127], a[0:15]
    v_mfma_f32_32x32x16_bf16 a[0:15], v[32:35], v[128:131], a[0:15]
    v_mfma_f32_32x32x16_bf16 a[0:15], v[36:39], v[132:135], a[0:15]
    v_mfma_f32_32x32x16_bf16 a[0:15], v[40:43], v[136:139], a[0:15]
    v_mfma_f32_32x32x16_bf16 a[0:15], v[44:47], v[140:143], a[0:15]
    s_waitcnt lgkmcnt(0)
    v_mfma_f32_32x32x16_bf16 a[16:31], v[48:51], v[112:115], a[16:31]
    ds_read_b64_tr_b16 v[16:17], v212 offset:128
    ds_read_b64_tr_b16 v[18:19], v212 offset:1664
    ds_read_b64_tr_b16 v[20:21], v212 offset:3200
    ds_read_b64_tr_b16 v[22:23], v212 offset:4736
    ds_read_b64_tr_b16 v[24:25], v212 offset:6272
    ds_read_b64_tr_b16 v[26:27], v212 offset:7808
    ds_read_b64_tr_b16 v[28:29], v212 offset:9344
    ds_read_b64_tr_b16 v[30:31], v212 offset:10880
    v_mfma_f32_32x32x16_bf16 a[16:31], v[52:55], v[116:119], a[16:31]
    ds_read_b64_tr_b16 v[32:33], v214 offset:128
    ds_read_b64_tr_b16 v[34:35], v214 offset:1664
    ds_read_b64_tr_b16 v[36:37], v214 offset:3200
    ds_read_b64_tr_b16 v[38:39], v214 offset:4736
    ds_read_b64_tr_b16 v[40:41], v214 offset:6272
    ds_read_b64_tr_b16 v[42:43], v214 offset:7808
    ds_read_b64_tr_b16 v[44:45], v214 offset:9344
    ds_read_b64_tr_b16 v[46:47], v214 offset:10880
    v_mfma_f32_32x32x16_bf16 a[16:31], v[56:59], v[120:123], a[16:31]
    s_mul_i32 s29, s25, 192
    s_add_u32 s29, s29, 0
    s_cmp_lt_u32 s29, 512
    s_cselect_b32 s31, 0x3eb8aa3b, 1.0
    v_accvgpr_read_b32 v80, a0
    v_accvgpr_read_b32 v81, a1
    v_accvgpr_read_b32 v82, a2
    v_accvgpr_read_b32 v83, a3
    v_accvgpr_read_b32 v84, a4
    v_mfma_f32_32x32x16_bf16 a[16:31], v[60:63], v[124:127], a[16:31]
    v_accvgpr_read_b32 v85, a5
    v_accvgpr_read_b32 v86, a6
    v_accvgpr_read_b32 v87, a7
    v_mul_f32 v80, s31, v80
    v_mul_f32 v81, s31, v81
    v_mul_f32 v82, s31, v82
    v_mul_f32 v83, s31, v83
    v_mul_f32 v84, s31, v84
    v_mul_f32 v85, s31, v85
    v_mfma_f32_32x32x16_bf16 a[16:31], v[64:67], v[128:131], a[16:31]
    v_mul_f32 v86, s31, v86
    v_mul_f32 v87, s31, v87
    v_cvt_pk_bf16_f32 v96, v80, v81
    v_cvt_pk_bf16_f32 v97, v82, v83
    v_cvt_pk_bf16_f32 v98, v84, v85
    v_cvt_pk_bf16_f32 v99, v86, v87
    s_add_u32 s29, s28, 0
    s_nop 0
    v_permlane32_swap_b32 v96, v98
    v_mfma_f32_32x32x16_bf16 a[16:31], v[68:71], v[132:135], a[16:31]
    v_permlane32_swap_b32 v97, v99
    buffer_store_dwordx4 v[96:99], v222, s[20:23], s29 offen sc1
    v_accvgpr_read_b32 v88, a8
    v_accvgpr_read_b32 v89, a9
    v_accvgpr_read_b32 v90, a10
    v_accvgpr_read_b32 v91, a11
    v_accvgpr_read_b32 v92, a12
    v_accvgpr_read_b32 v93, a13
    v_accvgpr_read_b32 v94, a14
    v_mfma_f32_32x32x16_bf16 a[16:31], v[72:75], v[136:139], a[16:31]
    v_accvgpr_read_b32 v95, a15
    v_mul_f32 v88, s31, v88
    v_mul_f32 v89, s31, v89
    v_mul_f32 v90, s31, v90
    v_mul_f32 v91, s31, v91
    v_mul_f32 v92, s31, v92
    v_mul_f32 v93, s31, v93
    v_mul_f32 v94, s31, v94
    v_mul_f32 v95, s31, v95
    v_mfma_f32_32x32x16_bf16 a[16:31], v[76:79], v[140:143], a[16:31]
    v_cvt_pk_bf16_f32 v100, v88, v89
    v_cvt_pk_bf16_f32 v101, v90, v91
    v_cvt_pk_bf16_f32 v102, v92, v93
    v_cvt_pk_bf16_f32 v103, v94, v95
    s_add_u32 s29, s28, 65536
    s_nop 0
    v_permlane32_swap_b32 v100, v102
    v_permlane32_swap_b32 v101, v103
    buffer_store_dwordx4 v[100:103], v222, s[20:23], s29 offen sc1
    s_waitcnt lgkmcnt(0)
    v_mfma_f32_32x32x16_bf16 a[32:47], v[16:19], v[112:115], a[32:47]
    ds_read_b64_tr_b16 v[48:49], v213 offset:192
    ds_read_b64_tr_b16 v[50:51], v213 offset:1728
    ds_read_b64_tr_b16 v[52:53], v213 offset:3264
    ds_read_b64_tr_b16 v[54:55], v213 offset:4800
    ds_read_b64_tr_b16 v[56:57], v213 offset:6336
    ds_read_b64_tr_b16 v[58:59], v213 offset:7872
    ds_read_b64_tr_b16 v[60:61], v213 offset:9408
    ds_read_b64_tr_b16 v[62:63], v213 offset:10944
    v_mfma_f32_32x32x16_bf16 a[32:47], v[20:23], v[116:119], a[32:47]
    ds_read_b64_tr_b16 v[64:65], v215 offset:192
    ds_read_b64_tr_b16 v[66:67], v215 offset:1728
    ds_read_b64_tr_b16 v[68:69], v215 offset:3264
    ds_read_b64_tr_b16 v[70:71], v215 offset:4800
    ds_read_b64_tr_b16 v[72:73], v215 offset:6336
    ds_read_b64_tr_b16 v[74:75], v215 offset:7872
    ds_read_b64_tr_b16 v[76:77], v215 offset:9408
    ds_read_b64_tr_b16 v[78:79], v215 offset:10944
    v_mfma_f32_32x32x16_bf16 a[32:47], v[24:27], v[120:123], a[32:47]
    s_mul_i32 s29, s25, 192
    s_add_u32 s29, s29, 32
    s_cmp_lt_u32 s29, 512
    s_cselect_b32 s31, 0x3eb8aa3b, 1.0
    v_accvgpr_read_b32 v80, a16
    v_accvgpr_read_b32 v81, a17
    v_accvgpr_read_b32 v82, a18
    v_accvgpr_read_b32 v83, a19
    v_accvgpr_read_b32 v84, a20
    v_mfma_f32_32x32x16_bf16 a[32:47], v[28:31], v[124:127], a[32:47]
    v_accvgpr_read_b32 v85, a21
    v_accvgpr_read_b32 v86, a22
    v_accvgpr_read_b32 v87, a23
    v_mul_f32 v80, s31, v80
    v_mul_f32 v81, s31, v81
    v_mul_f32 v82, s31, v82
    v_mul_f32 v83, s31, v83
    v_mul_f32 v84, s31, v84
    v_mul_f32 v85, s31, v85
    v_mfma_f32_32x32x16_bf16 a[32:47], v[32:35], v[128:131], a[32:47]
    v_mul_f32 v86, s31, v86
    v_mul_f32 v87, s31, v87
    v_cvt_pk_bf16_f32 v104, v80, v81
    v_cvt_pk_bf16_f32 v105, v82, v83
    v_cvt_pk_bf16_f32 v106, v84, v85
    v_cvt_pk_bf16_f32 v107, v86, v87
    s_add_u32 s29, s28, 131072
    s_nop 0
    v_permlane32_swap_b32 v104, v106
    v_mfma_f32_32x32x16_bf16 a[32:47], v[36:39], v[132:135], a[32:47]
    v_permlane32_swap_b32 v105, v107
    buffer_store_dwordx4 v[104:107], v222, s[20:23], s29 offen sc1
    v_accvgpr_read_b32 v88, a24
    v_accvgpr_read_b32 v89, a25
    v_accvgpr_read_b32 v90, a26
    v_accvgpr_read_b32 v91, a27
    v_accvgpr_read_b32 v92, a28
    v_accvgpr_read_b32 v93, a29
    v_accvgpr_read_b32 v94, a30
    v_mfma_f32_32x32x16_bf16 a[32:47], v[40:43], v[136:139], a[32:47]
    v_accvgpr_read_b32 v95, a31
    v_mul_f32 v88, s31, v88
    v_mul_f32 v89, s31, v89
    v_mul_f32 v90, s31, v90
    v_mul_f32 v91, s31, v91
    v_mul_f32 v92, s31, v92
    v_mul_f32 v93, s31, v93
    v_mul_f32 v94, s31, v94
    v_mul_f32 v95, s31, v95
    v_mfma_f32_32x32x16_bf16 a[32:47], v[44:47], v[140:143], a[32:47]
    v_cvt_pk_bf16_f32 v108, v88, v89
    v_cvt_pk_bf16_f32 v109, v90, v91
    v_cvt_pk_bf16_f32 v110, v92, v93
    v_cvt_pk_bf16_f32 v111, v94, v95
    s_add_u32 s29, s28, 196608
    s_nop 0
    v_permlane32_swap_b32 v108, v110
    v_permlane32_swap_b32 v109, v111
    buffer_store_dwordx4 v[108:111], v222, s[20:23], s29 offen sc1
    s_waitcnt lgkmcnt(0)
    v_mfma_f32_32x32x16_bf16 a[48:63], v[48:51], v[112:115], a[48:63]
    ds_read_b64_tr_b16 v[16:17], v212 offset:256
    ds_read_b64_tr_b16 v[18:19], v212 offset:1792
    ds_read_b64_tr_b16 v[20:21], v212 offset:3328
    ds_read_b64_tr_b16 v[22:23], v212 offset:4864
    ds_read_b64_tr_b16 v[24:25], v212 offset:6400
    ds_read_b64_tr_b16 v[26:27], v212 offset:7936
    ds_read_b64_tr_b16 v[28:29], v212 offset:9472
    ds_read_b64_tr_b16 v[30:31], v212 offset:11008
    v_mfma_f32_32x32x16_bf16 a[48:63], v[52:55], v[116:119], a[48:63]
    ds_read_b64_tr_b16 v[32:33], v214 offset:256
    ds_read_b64_tr_b16 v[34:35], v214 offset:1792
    ds_read_b64_tr_b16 v[36:37], v214 offset:3328
    ds_read_b64_tr_b16 v[38:39], v214 offset:4864
    ds_read_b64_tr_b16 v[40:41], v214 offset:6400
    ds_read_b64_tr_b16 v[42:43], v214 offset:7936
    ds_read_b64_tr_b16 v[44:45], v214 offset:9472
    ds_read_b64_tr_b16 v[46:47], v214 offset:11008
    v_mfma_f32_32x32x16_bf16 a[48:63], v[56:59], v[120:123], a[48:63]
    s_mul_i32 s29, s25, 192
    s_add_u32 s29, s29, 64
    s_cmp_lt_u32 s29, 512
    s_cselect_b32 s31, 0x3eb8aa3b, 1.0
    v_accvgpr_read_b32 v80, a32
    v_accvgpr_read_b32 v81, a33
    v_accvgpr_read_b32 v82, a34
    v_accvgpr_read_b32 v83, a35
    v_accvgpr_read_b32 v84, a36
    v_mfma_f32_32x32x16_bf16 a[48:63], v[60:63], v[124:127], a[48:63]
    v_accvgpr_read_b32 v85, a37
    v_accvgpr_read_b32 v86, a38
    v_accvgpr_read_b32 v87, a39
    v_mul_f32 v80, s31, v80
    v_mul_f32 v81, s31, v81
    v_mul_f32 v82, s31, v82
    v_mul_f32 v83, s31, v83
    v_mul_f32 v84, s31, v84
    v_mul_f32 v85, s31, v85
    v_mfma_f32_32x32x16_bf16 a[48:63], v[64:67], v[128:131], a[48:63]
    v_mul_f32 v86, s31, v86
    v_mul_f32 v87, s31, v87
    v_cvt_pk_bf16_f32 v96, v80, v81
    v_cvt_pk_bf16_f32 v97, v82, v83
    v_cvt_pk_bf16_f32 v98, v84, v85
    v_cvt_pk_bf16_f32 v99, v86, v87
    s_add_u32 s29, s28, 262144
    s_nop 0
    v_permlane32_swap_b32 v96, v98
    v_mfma_f32_32x32x16_bf16 a[48:63], v[68:71], v[132:135], a[48:63]
    v_permlane32_swap_b32 v97, v99
    buffer_store_dwordx4 v[96:99], v222, s[20:23], s29 offen sc1
    v_accvgpr_read_b32 v88, a40
    v_accvgpr_read_b32 v89, a41
    v_accvgpr_read_b32 v90, a42
    v_accvgpr_read_b32 v91, a43
    v_accvgpr_read_b32 v92, a44
    v_accvgpr_read_b32 v93, a45
    v_accvgpr_read_b32 v94, a46
    v_mfma_f32_32x32x16_bf16 a[48:63], v[72:75], v[136:139], a[48:63]
    v_accvgpr_read_b32 v95, a47
    v_mul_f32 v88, s31, v88
    v_mul_f32 v89, s31, v89
    v_mul_f32 v90, s31, v90
    v_mul_f32 v91, s31, v91
    v_mul_f32 v92, s31, v92
    v_mul_f32 v93, s31, v93
    v_mul_f32 v94, s31, v94
    v_mul_f32 v95, s31, v95
    v_mfma_f32_32x32x16_bf16 a[48:63], v[76:79], v[140:143], a[48:63]
    v_cvt_pk_bf16_f32 v100, v88, v89
    v_cvt_pk_bf16_f32 v101, v90, v91
    v_cvt_pk_bf16_f32 v102, v92, v93
    v_cvt_pk_bf16_f32 v103, v94, v95
    s_add_u32 s29, s28, 327680
    s_nop 0
    v_permlane32_swap_b32 v100, v102
    v_permlane32_swap_b32 v101, v103
    buffer_store_dwordx4 v[100:103], v222, s[20:23], s29 offen sc1
    s_waitcnt lgkmcnt(0)
    v_mfma_f32_32x32x16_bf16 a[64:79], v[16:19], v[112:115], a[64:79]
    ds_read_b64_tr_b16 v[48:49], v213 offset:320
    ds_read_b64_tr_b16 v[50:51], v213 offset:1856
    ds_read_b64_tr_b16 v[52:53], v213 offset:3392
    ds_read_b64_tr_b16 v[54:55], v213 offset:4928
    ds_read_b64_tr_b16 v[56:57], v213 offset:6464
    ds_read_b64_tr_b16 v[58:59], v213 offset:8000
    ds_read_b64_tr_b16 v[60:61], v213 offset:9536
    ds_read_b64_tr_b16 v[62:63], v213 offset:11072
    v_mfma_f32_32x32x16_bf16 a[64:79], v[20:23], v[116:119], a[64:79]
    ds_read_b64_tr_b16 v[64:65], v215 offset:320
    ds_read_b64_tr_b16 v[66:67], v215 offset:1856
    ds_read_b64_tr_b16 v[68:69], v215 offset:3392
    ds_read_b64_tr_b16 v[70:71], v215 offset:4928
    ds_read_b64_tr_b16 v[72:73], v215 offset:6464
    ds_read_b64_tr_b16 v[74:75], v215 offset:8000
    ds_read_b64_tr_b16 v[76:77], v215 offset:9536
    ds_read_b64_tr_b16 v[78:79], v215 offset:11072
    v_mfma_f32_32x32x16_bf16 a[64:79], v[24:27], v[120:123], a[64:79]
    s_mul_i32 s29, s25, 192
    s_add_u32 s29, s29, 96
    s_cmp_lt_u32 s29, 512
    s_cselect_b32 s31, 0x3eb8aa3b, 1.0
    v_accvgpr_read_b32 v80, a48
    v_accvgpr_read_b32 v81, a49
    v_accvgpr_read_b32 v82, a50
    v_accvgpr_read_b32 v83, a51
    v_accvgpr_read_b32 v84, a52
    v_mfma_f32_32x32x16_bf16 a[64:79], v[28:31], v[124:127], a[64:79]
    v_accvgpr_read_b32 v85, a53
    v_accvgpr_read_b32 v86, a54
    v_accvgpr_read_b32 v87, a55
    v_mul_f32 v80, s31, v80
    v_mul_f32 v81, s31, v81
    v_mul_f32 v82, s31, v82
    v_mul_f32 v83, s31, v83
    v_mul_f32 v84, s31, v84
    v_mul_f32 v85, s31, v85
    v_mfma_f32_32x32x16_bf16 a[64:79], v[32:35], v[128:131], a[64:79]
    v_mul_f32 v86, s31, v86
    v_mul_f32 v87, s31, v87
    v_cvt_pk_bf16_f32 v104, v80, v81
    v_cvt_pk_bf16_f32 v105, v82, v83
    v_cvt_pk_bf16_f32 v106, v84, v85
    v_cvt_pk_bf16_f32 v107, v86, v87
    s_add_u32 s29, s28, 393216
    s_nop 0
    v_permlane32_swap_b32 v104, v106
    v_mfma_f32_32x32x16_bf16 a[64:79], v[36:39], v[132:135], a[64:79]
    v_permlane32_swap_b32 v105, v107
    buffer_store_dwordx4 v[104:107], v222, s[20:23], s29 offen sc1
    v_accvgpr_read_b32 v88, a56
    v_accvgpr_read_b32 v89, a57
    v_accvgpr_read_b32 v90, a58
    v_accvgpr_read_b32 v91, a59
    v_accvgpr_read_b32 v92, a60
    v_accvgpr_read_b32 v93, a61
    v_accvgpr_read_b32 v94, a62
    v_mfma_f32_32x32x16_bf16 a[64:79], v[40:43], v[136:139], a[64:79]
    v_accvgpr_read_b32 v95, a63
    v_mul_f32 v88, s31, v88
    v_mul_f32 v89, s31, v89
    v_mul_f32 v90, s31, v90
    v_mul_f32 v91, s31, v91
    v_mul_f32 v92, s31, v92
    v_mul_f32 v93, s31, v93
    v_mul_f32 v94, s31, v94
    v_mul_f32 v95, s31, v95
    v_mfma_f32_32x32x16_bf16 a[64:79], v[44:47], v[140:143], a[64:79]
    v_cvt_pk_bf16_f32 v108, v88, v89
    v_cvt_pk_bf16_f32 v109, v90, v91
    v_cvt_pk_bf16_f32 v110, v92, v93
    v_cvt_pk_bf16_f32 v111, v94, v95
    s_add_u32 s29, s28, 458752
    s_nop 0
    v_permlane32_swap_b32 v108, v110
    v_permlane32_swap_b32 v109, v111
    buffer_store_dwordx4 v[108:111], v222, s[20:23], s29 offen sc1
    s_waitcnt lgkmcnt(0)
    v_mfma_f32_32x32x16_bf16 a[80:95], v[48:51], v[112:115], a[80:95]
    v_mfma_f32_32x32x16_bf16 a[80:95], v[52:55], v[116:119], a[80:95]
    v_mfma_f32_32x32x16_bf16 a[80:95], v[56:59], v[120:123], a[80:95]
    s_mul_i32 s29, s25, 192
    s_add_u32 s29, s29, 128
    s_cmp_lt_u32 s29, 512
    s_cselect_b32 s31, 0x3eb8aa3b, 1.0
    v_accvgpr_read_b32 v80, a64
    v_accvgpr_read_b32 v81, a65
    v_accvgpr_read_b32 v82, a66
    v_accvgpr_read_b32 v83, a67
    v_accvgpr_read_b32 v84, a68
    v_mfma_f32_32x32x16_bf16 a[80:95], v[60:63], v[124:127], a[80:95]
    v_accvgpr_read_b32 v85, a69
    v_accvgpr_read_b32 v86, a70
    v_accvgpr_read_b32 v87, a71
    v_mul_f32 v80, s31, v80
    v_mul_f32 v81, s31, v81
    v_mul_f32 v82, s31, v82
    v_mul_f32 v83, s31, v83
    v_mul_f32 v84, s31, v84
    v_mul_f32 v85, s31, v85
    v_mfma_f32_32x32x16_bf16 a[80:95], v[64:67], v[128:131], a[80:95]
    v_mul_f32 v86, s31, v86
    v_mul_f32 v87, s31, v87
    v_cvt_pk_bf16_f32 v96, v80, v81
    v_cvt_pk_bf16_f32 v97, v82, v83
    v_cvt_pk_bf16_f32 v98, v84, v85
    v_cvt_pk_bf16_f32 v99, v86, v87
    s_add_u32 s29, s28, 524288
    s_nop 0
    v_permlane32_swap_b32 v96, v98
    v_mfma_f32_32x32x16_bf16 a[80:95], v[68:71], v[132:135], a[80:95]
    v_permlane32_swap_b32 v97, v99
    buffer_store_dwordx4 v[96:99], v222, s[20:23], s29 offen sc1
    v_accvgpr_read_b32 v88, a72
    v_accvgpr_read_b32 v89, a73
    v_accvgpr_read_b32 v90, a74
    v_accvgpr_read_b32 v91, a75
    v_accvgpr_read_b32 v92, a76
    v_accvgpr_read_b32 v93, a77
    v_accvgpr_read_b32 v94, a78
    v_mfma_f32_32x32x16_bf16 a[80:95], v[72:75], v[136:139], a[80:95]
    v_accvgpr_read_b32 v95, a79
    v_mul_f32 v88, s31, v88
    v_mul_f32 v89, s31, v89
    v_mul_f32 v90, s31, v90
    v_mul_f32 v91, s31, v91
    v_mul_f32 v92, s31, v92
    v_mul_f32 v93, s31, v93
    v_mul_f32 v94, s31, v94
    v_mul_f32 v95, s31, v95
    v_mfma_f32_32x32x16_bf16 a[80:95], v[76:79], v[140:143], a[80:95]
    v_cvt_pk_bf16_f32 v100, v88, v89
    v_cvt_pk_bf16_f32 v101, v90, v91
    v_cvt_pk_bf16_f32 v102, v92, v93
    v_cvt_pk_bf16_f32 v103, v94, v95
    s_add_u32 s29, s28, 589824
    s_nop 0
    v_permlane32_swap_b32 v100, v102
    v_permlane32_swap_b32 v101, v103
    buffer_store_dwordx4 v[100:103], v222, s[20:23], s29 offen sc1
    s_nop 15
    s_nop 3
    s_mul_i32 s29, s25, 192
    s_add_u32 s29, s29, 160
    s_cmp_lt_u32 s29, 512
    s_cselect_b32 s31, 0x3eb8aa3b, 1.0
    v_accvgpr_read_b32 v80, a80
    v_accvgpr_read_b32 v81, a81
    v_accvgpr_read_b32 v82, a82
    v_accvgpr_read_b32 v83, a83
    v_accvgpr_read_b32 v84, a84
    v_accvgpr_read_b32 v85, a85
    v_accvgpr_read_b32 v86, a86
    v_accvgpr_read_b32 v87, a87
    v_mul_f32 v80, s31, v80
    v_mul_f32 v81, s31, v81
    v_mul_f32 v82, s31, v82
    v_mul_f32 v83, s31, v83
    v_mul_f32 v84, s31, v84
    v_mul_f32 v85, s31, v85
    v_mul_f32 v86, s31, v86
    v_mul_f32 v87, s31, v87
    v_cvt_pk_bf16_f32 v104, v80, v81
    v_cvt_pk_bf16_f32 v105, v82, v83
    v_cvt_pk_bf16_f32 v106, v84, v85
    v_cvt_pk_bf16_f32 v107, v86, v87
    s_add_u32 s29, s28, 655360
    s_nop 0
    v_permlane32_swap_b32 v104, v106
    v_permlane32_swap_b32 v105, v107
    buffer_store_dwordx4 v[104:107], v222, s[20:23], s29 offen sc1
    v_accvgpr_read_b32 v88, a88
    v_accvgpr_read_b32 v89, a89
    v_accvgpr_read_b32 v90, a90
    v_accvgpr_read_b32 v91, a91
    v_accvgpr_read_b32 v92, a92
    v_accvgpr_read_b32 v93, a93
    v_accvgpr_read_b32 v94, a94
    v_accvgpr_read_b32 v95, a95
    v_mul_f32 v88, s31, v88
    v_mul_f32 v89, s31, v89
    v_mul_f32 v90, s31, v90
    v_mul_f32 v91, s31, v91
    v_mul_f32 v92, s31, v92
    v_mul_f32 v93, s31, v93
    v_mul_f32 v94, s31, v94
    v_mul_f32 v95, s31, v95
    v_cvt_pk_bf16_f32 v108, v88, v89
    v_cvt_pk_bf16_f32 v109, v90, v91
    v_cvt_pk_bf16_f32 v110, v92, v93
    v_cvt_pk_bf16_f32 v111, v94, v95
    s_add_u32 s29, s28, 720896
    s_nop 0
    v_permlane32_swap_b32 v108, v110
    v_permlane32_swap_b32 v109, v111
    buffer_store_dwordx4 v[108:111], v222, s[20:23], s29 offen sc1
    s_endpgm
LA_ffn:
    s_mov_b32 s16, s8
    s_mov_b32 s17, s9
    s_mov_b32 s18, 1835008
    s_mov_b32 s19, 0x00020000
    s_add_u32 s20, s10, 8388608
    s_addc_u32 s21, s11, 0
    s_mov_b32 s22, 9437184
    s_mov_b32 s23, 0x00020000
    s_mul_i32 s27, s25, 448
    s_mul_i32 s28, s26, 448
    v_add_u32 v218, s28, v1
    s_mov_b32 s29, 9363
    v_add_u32 v219, 0, v218
    v_mul_lo_u32 v220, v219, s29
    v_lshrrev_b32 v220, 18, v220
    v_mul_u32_u24 v221, 28, v220
    v_sub_u32 v221, v219, v221
    v_lshrrev_b32 v222, 5, v220
    v_lshlrev_b32 v222, 8, v222
    v_and_b32 v223, 31, v220
    v_add_u32 v222, v222, v223
    v_mul_u32_u24 v222, 3584, v222
    v_lshl_add_u32 v222, v221, 4, v222
    v_add_u32 v200, s27, v222
    v_add_u32 v219, 64, v218
    v_mul_lo_u32 v220, v219, s29
    v_lshrrev_b32 v220, 18, v220
    v_mul_u32_u24 v221, 28, v220
    v_sub_u32 v221, v219, v221
    v_lshrrev_b32 v222, 5, v220
    v_lshlrev_b32 v222, 8, v222
    v_and_b32 v223, 31, v220
    v_add_u32 v222, v222, v223
    v_mul_u32_u24 v222, 3584, v222
    v_lshl_add_u32 v222, v221, 4, v222
    v_add_u32 v201, s27, v222
    v_add_u32 v219, 128, v218
    v_mul_lo_u32 v220, v219, s29
    v_lshrrev_b32 v220, 18, v220
    v_mul_u32_u24 v221, 28, v220
    v_sub_u32 v221, v219, v221
    v_lshrrev_b32 v222, 5, v220
    v_lshlrev_b32 v222, 8, v222
    v_and_b32 v223, 31, v220
    v_add_u32 v222, v222, v223
    v_mul_u32_u24 v222, 3584, v222
    v_lshl_add_u32 v222, v221, 4, v222
    v_add_u32 v202, s27, v222
    v_add_u32 v219, 192, v218
    v_mul_lo_u32 v220, v219, s29
    v_lshrrev_b32 v220, 18, v220
    v_mul_u32_u24 v221, 28, v220
    v_sub_u32 v221, v219, v221
    v_lshrrev_b32 v222, 5, v220
    v_lshlrev_b32 v222, 8, v222
    v_and_b32 v223, 31, v220
    v_add_u32 v222, v222, v223
    v_mul_u32_u24 v222, 3584, v222
    v_lshl_add_u32 v222, v221, 4, v222
    v_add_u32 v203, s27, v222
    v_add_u32 v219, 256, v218
    v_mul_lo_u32 v220, v219, s29
    v_lshrrev_b32 v220, 18, v220
    v_mul_u32_u24 v221, 28, v220
    v_sub_u32 v221, v219, v221
    v_lshrrev_b32 v222, 5, v220
    v_lshlrev_b32 v222, 8, v222
    v_and_b32 v223, 31, v220
    v_add_u32 v222, v222, v223
    v_mul_u32_u24 v222, 3584, v222
    v_lshl_add_u32 v222, v221, 4, v222
    v_add_u32 v204, s27, v222
    v_add_u32 v219, 320, v218
    v_mul_lo_u32 v220, v219, s29
    v_lshrrev_b32 v220, 18, v220
    v_mul_u32_u24 v221, 28, v220
    v_sub_u32 v221, v219, v221
    v_lshrrev_b32 v222, 5, v220
    v_lshlrev_b32 v222, 8, v222
    v_and_b32 v223, 31, v220
    v_add_u32 v222, v222, v223
    v_mul_u32_u24 v222, 3584, v222
    v_lshl_add_u32 v222, v221, 4, v222
    v_add_u32 v205, s27, v222
    v_add_u32 v219, 384, v218
    v_mul_lo_u32 v220, v219, s29
    v_lshrrev_b32 v220, 18, v220
    v_mul_u32_u24 v221, 28, v220
    v_sub_u32 v221, v219, v221
    v_lshrrev_b32 v222, 5, v220
    v_lshlrev_b32 v222, 8, v222
    v_and_b32 v223, 31, v220
    v_add_u32 v222, v222, v223
    v_mul_u32_u24 v222, 3584, v222
    v_lshl_add_u32 v222, v221, 4, v222
    v_add_u32 v206, s27, v222
    v_lshrrev_b32 v218, 5, v1
    v_lshlrev_b32 v218, 5, v218
    v_bfe_u32 v219, v1, 2, 2
    v_add_u32 v218, v218, v219
    v_mul_u32_u24 v218, 448, v218
    v_bfe_u32 v220, v1, 4, 1
    v_lshl_add_u32 v218, v220, 5, v218
    v_and_b32 v220, 3, v1
    v_lshl_add_u32 v218, v220, 3, v218
    v_add_u32 v208, 133120, v218
    v_add_u32 v209, 133120, v218
    v_add_u32 v210, 0, v218
    v_add_u32 v211, 0, v218
    v_add_u32 v212, 28672, v218
    v_add_u32 v213, 28672, v218
    v_add_u32 v214, 57344, v218
    v_add_u32 v215, 57344, v218
    s_mul_i32 s30, s26, 7168
    s_lshl_b32 s31, s63, 1
    s_add_u32 s31, s31, 0
    s_and_b32 s31, s31, 7
    s_mul_i32 s68, s31, 114688
    s_lshl_b32 s31, s63, 1
    s_add_u32 s31, s31, 1
    s_and_b32 s31, s31, 7
    s_mul_i32 s69, s31, 114688
    s_lshl_b32 s31, s63, 1
    s_add_u32 s31, s31, 2
    s_and_b32 s31, s31, 7
    s_mul_i32 s70, s31, 114688
    s_lshl_b32 s31, s63, 1
    s_add_u32 s31, s31, 3
    s_and_b32 s31, s31, 7
    s_mul_i32 s71, s31, 114688
    s_lshl_b32 s31, s63, 1
    s_add_u32 s31, s31, 4
    s_and_b32 s31, s31, 7
    s_mul_i32 s72, s31, 114688
    s_lshl_b32 s31, s63, 1
    s_add_u32 s31, s31, 5
    s_and_b32 s31, s31, 7
    s_mul_i32 s73, s31, 114688
    s_lshl_b32 s31, s63, 1
    s_add_u32 s31, s31, 6
    s_and_b32 s31, s31, 7
    s_mul_i32 s74, s31, 114688
    s_lshl_b32 s31, s63, 1
    s_add_u32 s31, s31, 7
    s_and_b32 s31, s31, 7
    s_mul_i32 s75, s31, 114688
    v_mov_b32 v218, 0
    v_mov_b32 v219, 0
    v_mov_b32 v220, 0
    v_mov_b32 v221, 0
    v_mov_b32 v222, 0x3f803f80
    s_add_u32 s28, s53, 98304
    v_lshlrev_b32 v223, 4, v1
    v_add_u32 v223, s28, v223
    v_bfe_u32 v224, v1, 2, 2
    v_lshl_add_u32 v224, v3, 3, v224
    v_lshlrev_b32 v224, 6, v224
    v_bfe_u32 v225, v1, 4, 1
    v_lshl_add_u32 v224, v225, 5, v224
    v_and_b32 v225, 3, v1
    v_lshl_add_u32 v224, v225, 3, v224
    v_add_u32 v224, s28, v224
    v_and_b32 v225, 31, v1
    v_lshlrev_b32 v225, 4, v225
    v_lshl_add_u32 v225, v3, 13, v225
    s_add_u32 s40, s10, 20971520
    s_addc_u32 s41, s11, 0
    s_mov_b32 s42, 2359296
    s_mov_b32 s43, 0x00020000
    s_waitcnt vmcnt(11)
    ds_read_b128 v[16:19], v8 offset:0
    ds_read_b128 v[20:23], v9 offset:0
    ds_read_b128 v[24:27], v10 offset:0
    ds_read_b128 v[28:31], v11 offset:0
    ds_read_b128 v[32:35], v12 offset:0
    ds_read_b128 v[36:39], v13 offset:0
    ds_read_b128 v[40:43], v14 offset:0
    ds_read_b128 v[44:47], v15 offset:0
    s_waitcnt lgkmcnt(7)
    v_dot2_f32_bf16 v218, v16, v222, v218
    v_dot2_f32_bf16 v220, v16, v16, v220
    v_dot2_f32_bf16 v219, v17, v222, v219
    v_dot2_f32_bf16 v221, v17, v17, v221
    s_add_u32 m0, s53, 65536
    s_add_u32 s31, s66, 0
    buffer_load_dwordx4 v4, s[12:15], s31 offen lds
    v_dot2_f32_bf16 v218, v18, v222, v218
    v_dot2_f32_bf16 v220, v18, v18, v220
    v_dot2_f32_bf16 v219, v19, v222, v219
    v_dot2_f32_bf16 v221, v19, v19, v221
    s_add_u32 m0, s53, 66560
    s_add_u32 s31, s66, 8192
    buffer_load_dwordx4 v5, s[12:15], s31 offen lds
    s_waitcnt lgkmcnt(6)
    v_dot2_f32_bf16 v218, v20, v222, v218
    v_dot2_f32_bf16 v220, v20, v20, v220
    v_dot2_f32_bf16 v219, v21, v222, v219
    v_dot2_f32_bf16 v221, v21, v21, v221
    s_add_u32 m0, s53, 67584
    s_add_u32 s31, s66, 16384
    buffer_load_dwordx4 v4, s[12:15], s31 offen lds
    v_dot2_f32_bf16 v218, v22, v222, v218
    v_dot2_f32_bf16 v220, v22, v22, v220
    v_dot2_f32_bf16 v219, v23, v222, v219
    v_dot2_f32_bf16 v221, v23, v23, v221
    s_add_u32 m0, s53, 68608
    s_add_u32 s31, s66, 24576
    buffer_load_dwordx4 v5, s[12:15], s31 offen lds
    s_waitcnt lgkmcnt(5)
    v_dot2_f32_bf16 v218, v24, v222, v218
    v_dot2_f32_bf16 v220, v24, v24, v220
    v_dot2_f32_bf16 v219, v25, v222, v219
    v_dot2_f32_bf16 v221, v25, v25, v221
    s_add_u32 m0, s53, 81920
    s_add_u32 s31, s66, 512
    buffer_load_dwordx4 v4, s[12:15], s31 offen lds
    v_dot2_f32_bf16 v218, v26, v222, v218
    v_dot2_f32_bf16 v220, v26, v26, v220
    v_dot2_f32_bf16 v219, v27, v222, v219
    v_dot2_f32_bf16 v221, v27, v27, v221
    s_add_u32 m0, s53, 82944
    s_add_u32 s31, s66, 8704
    buffer_load_dwordx4 v5, s[12:15], s31 offen lds
    s_waitcnt lgkmcnt(4)
    v_dot2_f32_bf16 v218, v28, v222, v218
    v_dot2_f32_bf16 v220, v28, v28, v220
    v_dot2_f32_bf16 v219, v29, v222, v219
    v_dot2_f32_bf16 v221, v29, v29, v221
    s_add_u32 m0, s53, 83968
    s_add_u32 s31, s66, 16896
    buffer_load_dwordx4 v4, s[12:15], s31 offen lds
    v_dot2_f32_bf16 v218, v30, v222, v218
    v_dot2_f32_bf16 v220, v30, v30, v220
    v_dot2_f32_bf16 v219, v31, v222, v219
    v_dot2_f32_bf16 v221, v31, v31, v221
    s_add_u32 m0, s53, 84992
    s_add_u32 s31, s66, 25088
    buffer_load_dwordx4 v5, s[12:15], s31 offen lds
    s_waitcnt lgkmcnt(3)
    v_dot2_f32_bf16 v218, v32, v222, v218
    v_dot2_f32_bf16 v220, v32, v32, v220
    v_dot2_f32_bf16 v219, v33, v222, v219
    v_dot2_f32_bf16 v221, v33, v33, v221
    v_dot2_f32_bf16 v218, v34, v222, v218
    v_dot2_f32_bf16 v220, v34, v34, v220
    v_dot2_f32_bf16 v219, v35, v222, v219
    v_dot2_f32_bf16 v221, v35, v35, v221
    s_waitcnt lgkmcnt(2)
    v_dot2_f32_bf16 v218, v36, v222, v218
    v_dot2_f32_bf16 v220, v36, v36, v220
    v_dot2_f32_bf16 v219, v37, v222, v219
    v_dot2_f32_bf16 v221, v37, v37, v221
    v_dot2_f32_bf16 v218, v38, v222, v218
    v_dot2_f32_bf16 v220, v38, v38, v220
    v_dot2_f32_bf16 v219, v39, v222, v219
    v_dot2_f32_bf16 v221, v39, v39, v221
    s_waitcnt lgkmcnt(1)
    v_dot2_f32_bf16 v218, v40, v222, v218
    v_dot2_f32_bf16 v220, v40, v40, v220
    v_dot2_f32_bf16 v219, v41, v222, v219
    v_dot2_f32_bf16 v221, v41, v41, v221
    v_dot2_f32_bf16 v218, v42, v222, v218
    v_dot2_f32_bf16 v220, v42, v42, v220
    v_dot2_f32_bf16 v219, v43, v222, v219
    v_dot2_f32_bf16 v221, v43, v43, v221
    s_waitcnt lgkmcnt(0)
    v_dot2_f32_bf16 v218, v44, v222, v218
    v_dot2_f32_bf16 v220, v44, v44, v220
    v_dot2_f32_bf16 v219, v45, v222, v219
    v_dot2_f32_bf16 v221, v45, v45, v221
    v_dot2_f32_bf16 v218, v46, v222, v218
    v_dot2_f32_bf16 v220, v46, v46, v220
    v_dot2_f32_bf16 v219, v47, v222, v219
    v_dot2_f32_bf16 v221, v47, v47, v221
    s_waitcnt vmcnt(11)
    ds_read_b128 v[48:51], v8 offset:32768
    ds_read_b128 v[52:55], v9 offset:32768
    ds_read_b128 v[56:59], v10 offset:32768
    ds_read_b128 v[60:63], v11 offset:32768
    ds_read_b128 v[64:67], v12 offset:32768
    ds_read_b128 v[68:71], v13 offset:32768
    ds_read_b128 v[72:75], v14 offset:32768
    ds_read_b128 v[76:79], v15 offset:32768
    s_waitcnt lgkmcnt(7)
    v_dot2_f32_bf16 v218, v48, v222, v218
    v_dot2_f32_bf16 v220, v48, v48, v220
    v_dot2_f32_bf16 v219, v49, v222, v219
    v_dot2_f32_bf16 v221, v49, v49, v221
    s_add_u32 m0, s53, 98304
    s_add_u32 s31, s67, 0
    buffer_load_dwordx4 v4, s[12:15], s31 offen lds
    v_dot2_f32_bf16 v218, v50, v222, v218
    v_dot2_f32_bf16 v220, v50, v50, v220
    v_dot2_f32_bf16 v219, v51, v222, v219
    v_dot2_f32_bf16 v221, v51, v51, v221
    s_add_u32 m0, s53, 99328
    s_add_u32 s31, s67, 8192
    buffer_load_dwordx4 v5, s[12:15], s31 offen lds
    s_waitcnt lgkmcnt(6)
    v_dot2_f32_bf16 v218, v52, v222, v218
    v_dot2_f32_bf16 v220, v52, v52, v220
    v_dot2_f32_bf16 v219, v53, v222, v219
    v_dot2_f32_bf16 v221, v53, v53, v221
    s_add_u32 m0, s53, 100352
    s_add_u32 s31, s67, 16384
    buffer_load_dwordx4 v4, s[12:15], s31 offen lds
    v_dot2_f32_bf16 v218, v54, v222, v218
    v_dot2_f32_bf16 v220, v54, v54, v220
    v_dot2_f32_bf16 v219, v55, v222, v219
    v_dot2_f32_bf16 v221, v55, v55, v221
    s_add_u32 m0, s53, 101376
    s_add_u32 s31, s67, 24576
    buffer_load_dwordx4 v5, s[12:15], s31 offen lds
    s_waitcnt lgkmcnt(5)
    v_dot2_f32_bf16 v218, v56, v222, v218
    v_dot2_f32_bf16 v220, v56, v56, v220
    v_dot2_f32_bf16 v219, v57, v222, v219
    v_dot2_f32_bf16 v221, v57, v57, v221
    s_add_u32 m0, s53, 114688
    s_add_u32 s31, s67, 512
    buffer_load_dwordx4 v4, s[12:15], s31 offen lds
    v_dot2_f32_bf16 v218, v58, v222, v218
    v_dot2_f32_bf16 v220, v58, v58, v220
    v_dot2_f32_bf16 v219, v59, v222, v219
    v_dot2_f32_bf16 v221, v59, v59, v221
    s_add_u32 m0, s53, 115712
    s_add_u32 s31, s67, 8704
    buffer_load_dwordx4 v5, s[12:15], s31 offen lds
    s_waitcnt lgkmcnt(4)
    v_dot2_f32_bf16 v218, v60, v222, v218
    v_dot2_f32_bf16 v220, v60, v60, v220
    v_dot2_f32_bf16 v219, v61, v222, v219
    v_dot2_f32_bf16 v221, v61, v61, v221
    s_add_u32 m0, s53, 116736
    s_add_u32 s31, s67, 16896
    buffer_load_dwordx4 v4, s[12:15], s31 offen lds
    v_dot2_f32_bf16 v218, v62, v222, v218
    v_dot2_f32_bf16 v220, v62, v62, v220
    v_dot2_f32_bf16 v219, v63, v222, v219
    v_dot2_f32_bf16 v221, v63, v63, v221
    s_add_u32 m0, s53, 117760
    s_add_u32 s31, s67, 25088
    buffer_load_dwordx4 v5, s[12:15], s31 offen lds
    s_waitcnt lgkmcnt(3)
    v_dot2_f32_bf16 v218, v64, v222, v218
    v_dot2_f32_bf16 v220, v64, v64, v220
    v_dot2_f32_bf16 v219, v65, v222, v219
    v_dot2_f32_bf16 v221, v65, v65, v221
    v_dot2_f32_bf16 v218, v66, v222, v218
    v_dot2_f32_bf16 v220, v66, v66, v220
    v_dot2_f32_bf16 v219, v67, v222, v219
    v_dot2_f32_bf16 v221, v67, v67, v221
    s_waitcnt lgkmcnt(2)
    v_dot2_f32_bf16 v218, v68, v222, v218
    v_dot2_f32_bf16 v220, v68, v68, v220
    v_dot2_f32_bf16 v219, v69, v222, v219
    v_dot2_f32_bf16 v221, v69, v69, v221
    v_dot2_f32_bf16 v218, v70, v222, v218
    v_dot2_f32_bf16 v220, v70, v70, v220
    v_dot2_f32_bf16 v219, v71, v222, v219
    v_dot2_f32_bf16 v221, v71, v71, v221
    s_waitcnt lgkmcnt(1)
    v_dot2_f32_bf16 v218, v72, v222, v218
    v_dot2_f32_bf16 v220, v72, v72, v220
    v_dot2_f32_bf16 v219, v73, v222, v219
    v_dot2_f32_bf16 v221, v73, v73, v221
    v_dot2_f32_bf16 v218, v74, v222, v218
    v_dot2_f32_bf16 v220, v74, v74, v220
    v_dot2_f32_bf16 v219, v75, v222, v219
    v_dot2_f32_bf16 v221, v75, v75, v221
    s_waitcnt lgkmcnt(0)
    v_dot2_f32_bf16 v218, v76, v222, v218
    v_dot2_f32_bf16 v220, v76, v76, v220
    v_dot2_f32_bf16 v219, v77, v222, v219
    v_dot2_f32_bf16 v221, v77, v77, v221
    v_dot2_f32_bf16 v218, v78, v222, v218
    v_dot2_f32_bf16 v220, v78, v78, v220
    v_dot2_f32_bf16 v219, v79, v222, v219
    v_dot2_f32_bf16 v221, v79, v79, v221
    s_barrier
    v_add_u32 v8, 65536, v8
    v_add_u32 v9, 65536, v9
    v_add_u32 v10, 65536, v10
    v_add_u32 v11, 65536, v11
    v_add_u32 v12, 65536, v12
    v_add_u32 v13, 65536, v13
    v_add_u32 v14, 65536, v14
    v_add_u32 v15, 65536, v15
    s_waitcnt vmcnt(8)
    ds_read_b128 v[80:83], v8 offset:0
    ds_read_b128 v[84:87], v9 offset:0
    ds_read_b128 v[88:91], v10 offset:0
    ds_read_b128 v[92:95], v11 offset:0
    ds_read_b128 v[96:99], v12 offset:0
    ds_read_b128 v[100:103], v13 offset:0
    ds_read_b128 v[104:107], v14 offset:0
    ds_read_b128 v[108:111], v15 offset:0
    s_waitcnt lgkmcnt(7)
    v_dot2_f32_bf16 v218, v80, v222, v218
    v_dot2_f32_bf16 v220, v80, v80, v220
    v_dot2_f32_bf16 v219, v81, v222, v219
    v_dot2_f32_bf16 v221, v81, v81, v221
    s_add_u32 m0, s30, 133120
    buffer_load_dwordx4 v200, s[16:19], s68 offen lds
    v_dot2_f32_bf16 v218, v82, v222, v218
    v_dot2_f32_bf16 v220, v82, v82, v220
    v_dot2_f32_bf16 v219, v83, v222, v219
    v_dot2_f32_bf16 v221, v83, v83, v221
    s_add_u32 m0, s30, 134144
    buffer_load_dwordx4 v201, s[16:19], s68 offen lds
    s_waitcnt lgkmcnt(6)
    v_dot2_f32_bf16 v218, v84, v222, v218
    v_dot2_f32_bf16 v220, v84, v84, v220
    v_dot2_f32_bf16 v219, v85, v222, v219
    v_dot2_f32_bf16 v221, v85, v85, v221
    s_add_u32 m0, s30, 135168
    buffer_load_dwordx4 v202, s[16:19], s68 offen lds
    v_dot2_f32_bf16 v218, v86, v222, v218
    v_dot2_f32_bf16 v220, v86, v86, v220
    v_dot2_f32_bf16 v219, v87, v222, v219
    v_dot2_f32_bf16 v221, v87, v87, v221
    s_add_u32 m0, s30, 136192
    buffer_load_dwordx4 v203, s[16:19], s68 offen lds
    s_waitcnt lgkmcnt(5)
    v_dot2_f32_bf16 v218, v88, v222, v218
    v_dot2_f32_bf16 v220, v88, v88, v220
    v_dot2_f32_bf16 v219, v89, v222, v219
    v_dot2_f32_bf16 v221, v89, v89, v221
    s_add_u32 m0, s30, 137216
    buffer_load_dwordx4 v204, s[16:19], s68 offen lds
    v_dot2_f32_bf16 v218, v90, v222, v218
    v_dot2_f32_bf16 v220, v90, v90, v220
    v_dot2_f32_bf16 v219, v91, v222, v219
    v_dot2_f32_bf16 v221, v91, v91, v221
    s_add_u32 m0, s30, 138240
    buffer_load_dwordx4 v205, s[16:19], s68 offen lds
    s_waitcnt lgkmcnt(4)
    v_dot2_f32_bf16 v218, v92, v222, v218
    v_dot2_f32_bf16 v220, v92, v92, v220
    v_dot2_f32_bf16 v219, v93, v222, v219
    v_dot2_f32_bf16 v221, v93, v93, v221
    s_add_u32 m0, s30, 139264
    buffer_load_dwordx4 v206, s[16:19], s68 offen lds
    v_dot2_f32_bf16 v218, v94, v222, v218
    v_dot2_f32_bf16 v220, v94, v94, v220
    v_dot2_f32_bf16 v219, v95, v222, v219
    v_dot2_f32_bf16 v221, v95, v95, v221
    s_waitcnt lgkmcnt(3)
    v_dot2_f32_bf16 v218, v96, v222, v218
    v_dot2_f32_bf16 v220, v96, v96, v220
    v_dot2_f32_bf16 v219, v97, v222, v219
    v_dot2_f32_bf16 v221, v97, v97, v221
    v_dot2_f32_bf16 v218, v98, v222, v218
    v_dot2_f32_bf16 v220, v98, v98, v220
    v_dot2_f32_bf16 v219, v99, v222, v219
    v_dot2_f32_bf16 v221, v99, v99, v221
    s_waitcnt lgkmcnt(2)
    v_dot2_f32_bf16 v218, v100, v222, v218
    v_dot2_f32_bf16 v220, v100, v100, v220
    v_dot2_f32_bf16 v219, v101, v222, v219
    v_dot2_f32_bf16 v221, v101, v101, v221
    v_dot2_f32_bf16 v218, v102, v222, v218
    v_dot2_f32_bf16 v220, v102, v102, v220
    v_dot2_f32_bf16 v219, v103, v222, v219
    v_dot2_f32_bf16 v221, v103, v103, v221
    s_waitcnt lgkmcnt(1)
    v_dot2_f32_bf16 v218, v104, v222, v218
    v_dot2_f32_bf16 v220, v104, v104, v220
    v_dot2_f32_bf16 v219, v105, v222, v219
    v_dot2_f32_bf16 v221, v105, v105, v221
    v_dot2_f32_bf16 v218, v106, v222, v218
    v_dot2_f32_bf16 v220, v106, v106, v220
    v_dot2_f32_bf16 v219, v107, v222, v219
    v_dot2_f32_bf16 v221, v107, v107, v221
    s_waitcnt lgkmcnt(0)
    v_dot2_f32_bf16 v218, v108, v222, v218
    v_dot2_f32_bf16 v220, v108, v108, v220
    v_dot2_f32_bf16 v219, v109, v222, v219
    v_dot2_f32_bf16 v221, v109, v109, v221
    v_dot2_f32_bf16 v218, v110, v222, v218
    v_dot2_f32_bf16 v220, v110, v110, v220
    v_dot2_f32_bf16 v219, v111, v222, v219
    v_dot2_f32_bf16 v221, v111, v111, v221
    s_waitcnt vmcnt(7)
    ds_read_b128 v[112:115], v8 offset:32768
    ds_read_b128 v[116:119], v9 offset:32768
    ds_read_b128 v[120:123], v10 offset:32768
    ds_read_b128 v[124:127], v11 offset:32768
    ds_read_b128 v[128:131], v12 offset:32768
    ds_read_b128 v[132:135], v13 offset:32768
    ds_read_b128 v[136:139], v14 offset:32768
    ds_read_b128 v[140:143], v15 offset:32768
    s_waitcnt lgkmcnt(7)
    v_dot2_f32_bf16 v218, v112, v222, v218
    v_dot2_f32_bf16 v220, v112, v112, v220
    v_dot2_f32_bf16 v219, v113, v222, v219
    v_dot2_f32_bf16 v221, v113, v113, v221
    s_add_u32 m0, s30, 0
    buffer_load_dwordx4 v200, s[16:19], s69 offen lds
    v_dot2_f32_bf16 v218, v114, v222, v218
    v_dot2_f32_bf16 v220, v114, v114, v220
    v_dot2_f32_bf16 v219, v115, v222, v219
    v_dot2_f32_bf16 v221, v115, v115, v221
    s_add_u32 m0, s30, 1024
    buffer_load_dwordx4 v201, s[16:19], s69 offen lds
    s_waitcnt lgkmcnt(6)
    v_dot2_f32_bf16 v218, v116, v222, v218
    v_dot2_f32_bf16 v220, v116, v116, v220
    v_dot2_f32_bf16 v219, v117, v222, v219
    v_dot2_f32_bf16 v221, v117, v117, v221
    s_add_u32 m0, s30, 2048
    buffer_load_dwordx4 v202, s[16:19], s69 offen lds
    v_dot2_f32_bf16 v218, v118, v222, v218
    v_dot2_f32_bf16 v220, v118, v118, v220
    v_dot2_f32_bf16 v219, v119, v222, v219
    v_dot2_f32_bf16 v221, v119, v119, v221
    s_add_u32 m0, s30, 3072
    buffer_load_dwordx4 v203, s[16:19], s69 offen lds
    s_waitcnt lgkmcnt(5)
    v_dot2_f32_bf16 v218, v120, v222, v218
    v_dot2_f32_bf16 v220, v120, v120, v220
    v_dot2_f32_bf16 v219, v121, v222, v219
    v_dot2_f32_bf16 v221, v121, v121, v221
    s_add_u32 m0, s30, 4096
    buffer_load_dwordx4 v204, s[16:19], s69 offen lds
    v_dot2_f32_bf16 v218, v122, v222, v218
    v_dot2_f32_bf16 v220, v122, v122, v220
    v_dot2_f32_bf16 v219, v123, v222, v219
    v_dot2_f32_bf16 v221, v123, v123, v221
    s_add_u32 m0, s30, 5120
    buffer_load_dwordx4 v205, s[16:19], s69 offen lds
    s_waitcnt lgkmcnt(4)
    v_dot2_f32_bf16 v218, v124, v222, v218
    v_dot2_f32_bf16 v220, v124, v124, v220
    v_dot2_f32_bf16 v219, v125, v222, v219
    v_dot2_f32_bf16 v221, v125, v125, v221
    s_add_u32 m0, s30, 6144
    buffer_load_dwordx4 v206, s[16:19], s69 offen lds
    v_dot2_f32_bf16 v218, v126, v222, v218
    v_dot2_f32_bf16 v220, v126, v126, v220
    v_dot2_f32_bf16 v219, v127, v222, v219
    v_dot2_f32_bf16 v221, v127, v127, v221
    s_add_u32 m0, s30, 28672
    buffer_load_dwordx4 v200, s[16:19], s70 offen lds
    s_waitcnt lgkmcnt(3)
    v_dot2_f32_bf16 v218, v128, v222, v218
    v_dot2_f32_bf16 v220, v128, v128, v220
    v_dot2_f32_bf16 v219, v129, v222, v219
    v_dot2_f32_bf16 v221, v129, v129, v221
    s_add_u32 m0, s30, 29696
    buffer_load_dwordx4 v201, s[16:19], s70 offen lds
    v_dot2_f32_bf16 v218, v130, v222, v218
    v_dot2_f32_bf16 v220, v130, v130, v220
    v_dot2_f32_bf16 v219, v131, v222, v219
    v_dot2_f32_bf16 v221, v131, v131, v221
    s_add_u32 m0, s30, 30720
    buffer_load_dwordx4 v202, s[16:19], s70 offen lds
    s_waitcnt lgkmcnt(2)
    v_dot2_f32_bf16 v218, v132, v222, v218
    v_dot2_f32_bf16 v220, v132, v132, v220
    v_dot2_f32_bf16 v219, v133, v222, v219
    v_dot2_f32_bf16 v221, v133, v133, v221
    s_add_u32 m0, s30, 31744
    buffer_load_dwordx4 v203, s[16:19], s70 offen lds
    v_dot2_f32_bf16 v218, v134, v222, v218
    v_dot2_f32_bf16 v220, v134, v134, v220
    v_dot2_f32_bf16 v219, v135, v222, v219
    v_dot2_f32_bf16 v221, v135, v135, v221
    s_add_u32 m0, s30, 32768
    buffer_load_dwordx4 v204, s[16:19], s70 offen lds
    s_waitcnt lgkmcnt(1)
    v_dot2_f32_bf16 v218, v136, v222, v218
    v_dot2_f32_bf16 v220, v136, v136, v220
    v_dot2_f32_bf16 v219, v137, v222, v219
    v_dot2_f32_bf16 v221, v137, v137, v221
    s_add_u32 m0, s30, 33792
    buffer_load_dwordx4 v205, s[16:19], s70 offen lds
    v_dot2_f32_bf16 v218, v138, v222, v218
    v_dot2_f32_bf16 v220, v138, v138, v220
    v_dot2_f32_bf16 v219, v139, v222, v219
    v_dot2_f32_bf16 v221, v139, v139, v221
    s_add_u32 m0, s30, 34816
    buffer_load_dwordx4 v206, s[16:19], s70 offen lds
    s_waitcnt lgkmcnt(0)
    v_dot2_f32_bf16 v218, v140, v222, v218
    v_dot2_f32_bf16 v220, v140, v140, v220
    v_dot2_f32_bf16 v219, v141, v222, v219
    v_dot2_f32_bf16 v221, v141, v141, v221
    v_dot2_f32_bf16 v218, v142, v222, v218
    v_dot2_f32_bf16 v220, v142, v142, v220
    v_dot2_f32_bf16 v219, v143, v222, v219
    v_dot2_f32_bf16 v221, v143, v143, v221
    ds_write_b128 v223, v[232:235] offset:0
    ds_write_b128 v223, v[236:239] offset:1024
    ds_write_b128 v223, v[240:243] offset:2048
    s_waitcnt lgkmcnt(0)
    ds_read_b64_tr_b16 v[232:233], v224 offset:0
    ds_read_b64_tr_b16 v[234:235], v224 offset:256
    ds_read_b64_tr_b16 v[236:237], v224 offset:1024
    ds_read_b64_tr_b16 v[238:239], v224 offset:1280
    ds_read_b64_tr_b16 v[240:241], v224 offset:2048
    ds_read_b64_tr_b16 v[242:243], v224 offset:2304
    s_nop 3
    v_add_f32 v218, v218, v219
    v_add_f32 v220, v220, v221
    v_mov_b32 v219, v218
    v_mov_b32 v221, v220
    s_nop 1
    v_permlane32_swap_b32 v218, v219
    v_permlane32_swap_b32 v220, v221
    s_nop 1
    v_add_f32 v218, v218, v219
    v_add_f32 v220, v220, v221
    v_mul_f32 v218, 0x3b000000, v218
    v_mul_f32 v220, 0x3b000000, v220
    v_fma_f32 v220, -v218, v218, v220
    v_max_f32 v220, 0, v220
    v_cvt_pk_bf16_f32 v218, v218, v220
    v_and_b32 v220, 0xffff0000, v218
    v_lshlrev_b32 v218, 16, v218
    v_add_f32 v220, 0x3727c5ac, v220
    v_cvt_pk_bf16_f32 v220, v220, v220
    v_and_b32 v220, 0xffff0000, v220
    v_sqrt_f32 v220, v220
    s_nop 0
    v_cvt_pk_bf16_f32 v220, v220, v220
    v_and_b32 v220, 0xffff0000, v220
    v_rcp_f32 v216, v220
    s_nop 0
    v_mul_f32 v217, v218, v216
    v_sub_f32 v217, 0, v217
    v_lshlrev_b32 v218, 16, v16
    v_and_b32 v219, 0xffff0000, v16
    v_fma_f32 v218, v218, v216, v217
    v_fma_f32 v219, v219, v216, v217
    v_cvt_pk_bf16_f32 v16, v218, v219
    v_lshlrev_b32 v220, 16, v17
    v_and_b32 v221, 0xffff0000, v17
    v_fma_f32 v220, v220, v216, v217
    v_fma_f32 v221, v221, v216, v217
    v_cvt_pk_bf16_f32 v17, v220, v221
    v_lshlrev_b32 v218, 16, v18
    v_and_b32 v219, 0xffff0000, v18
    v_fma_f32 v218, v218, v216, v217
    v_fma_f32 v219, v219, v216, v217
    v_cvt_pk_bf16_f32 v18, v218, v219
    v_lshlrev_b32 v220, 16, v19
    v_and_b32 v221, 0xffff0000, v19
    v_fma_f32 v220, v220, v216, v217
    v_fma_f32 v221, v221, v216, v217
    v_cvt_pk_bf16_f32 v19, v220, v221
    s_waitcnt lgkmcnt(0)
    s_add_u32 s49, s48, 0
    s_lshr_b32 s50, s49, 4
    s_and_b32 s51, s49, 15
    s_lshl_b32 s50, s50, 14
    s_lshl_b32 s51, s51, 9
    s_add_u32 s50, s50, s51
    buffer_store_dwordx4 v[232:235], v225, s[40:43], s50 offen sc1
    s_add_u32 s49, s48, 768
    s_lshr_b32 s50, s49, 4
    s_and_b32 s51, s49, 15
    s_lshl_b32 s50, s50, 14
    s_lshl_b32 s51, s51, 9
    s_add_u32 s50, s50, s51
    buffer_store_dwordx4 v[236:239], v225, s[40:43], s50 offen sc1
    s_add_u32 s49, s48, 1536
    s_lshr_b32 s50, s49, 4
    s_and_b32 s51, s49, 15
    s_lshl_b32 s50, s50, 14
    s_lshl_b32 s51, s51, 9
    s_add_u32 s50, s50, s51
    buffer_store_dwordx4 v[240:243], v225, s[40:43], s50 offen sc1
    s_waitcnt vmcnt(17)
    s_barrier
    ds_read_b64_tr_b16 v[144:145], v208 offset:0
    ds_read_b64_tr_b16 v[146:147], v208 offset:1792
    ds_read_b64_tr_b16 v[148:149], v209 offset:64
    ds_read_b64_tr_b16 v[150:151], v209 offset:1856
    ds_read_b64_tr_b16 v[152:153], v208 offset:128
    ds_read_b64_tr_b16 v[154:155], v208 offset:1920
    ds_read_b64_tr_b16 v[156:157], v209 offset:192
    ds_read_b64_tr_b16 v[158:159], v209 offset:1984
    ds_read_b64_tr_b16 v[160:161], v208 offset:256
    ds_read_b64_tr_b16 v[162:163], v208 offset:2048
    ds_read_b64_tr_b16 v[164:165], v209 offset:320
    ds_read_b64_tr_b16 v[166:167], v209 offset:2112
    ds_read_b64_tr_b16 v[168:169], v208 offset:384
    ds_read_b64_tr_b16 v[170:171], v208 offset:2176
    s_waitcnt lgkmcnt(10)
    v_mfma_f32_32x32x16_bf16 a[0:15], v[144:147], v[16:19], 0
    ds_read_b64_tr_b16 v[172:173], v208 offset:3584
    ds_read_b64_tr_b16 v[174:175], v208 offset:5376
    v_lshlrev_b32 v218, 16, v20
    v_and_b32 v219, 0xffff0000, v20
    v_fma_f32 v218, v218, v216, v217
    v_mfma_f32_32x32x16_bf16 a[16:31], v[148:151], v[16:19], 0
    ds_read_b64_tr_b16 v[176:177], v209 offset:3648
    ds_read_b64_tr_b16 v[178:179], v209 offset:5440
    v_fma_f32 v219, v219, v216, v217
    v_cvt_pk_bf16_f32 v20, v218, v219
    v_lshlrev_b32 v220, 16, v21
    s_waitcnt lgkmcnt(10)
    v_mfma_f32_32x32x16_bf16 a[32:47], v[152:155], v[16:19], 0
    ds_read_b64_tr_b16 v[180:181], v208 offset:3712
    ds_read_b64_tr_b16 v[182:183], v208 offset:5504
    v_and_b32 v221, 0xffff0000, v21
    v_fma_f32 v220, v220, v216, v217
    v_fma_f32 v221, v221, v216, v217
    v_mfma_f32_32x32x16_bf16 a[48:63], v[156:159], v[16:19], 0
    ds_read_b64_tr_b16 v[184:185], v209 offset:3776
    ds_read_b64_tr_b16 v[186:187], v209 offset:5568
    v_cvt_pk_bf16_f32 v21, v220, v221
    v_lshlrev_b32 v218, 16, v22
    v_and_b32 v219, 0xffff0000, v22
    s_waitcnt lgkmcnt(10)
    v_mfma_f32_32x32x16_bf16 a[64:79], v[160:163], v[16:19], 0
    ds_read_b64_tr_b16 v[188:189], v208 offset:3840
    ds_read_b64_tr_b16 v[190:191], v208 offset:5632
    v_fma_f32 v218, v218, v216, v217
    v_fma_f32 v219, v219, v216, v217
    v_cvt_pk_bf16_f32 v22, v218, v219
    v_mfma_f32_32x32x16_bf16 a[80:95], v[164:167], v[16:19], 0
    ds_read_b64_tr_b16 v[192:193], v209 offset:3904
    ds_read_b64_tr_b16 v[194:195], v209 offset:5696
    v_lshlrev_b32 v220, 16, v23
    v_and_b32 v221, 0xffff0000, v23
    v_fma_f32 v220, v220, v216, v217
    s_waitcnt lgkmcnt(12)
    v_mfma_f32_32x32x16_bf16 a[96:111], v[168:171], v[16:19], 0
    ds_read_b64_tr_b16 v[196:197], v208 offset:3968
    ds_read_b64_tr_b16 v[198:199], v208 offset:5760
    v_fma_f32 v221, v221, v216, v217
    v_cvt_pk_bf16_f32 v23, v220, v221
    s_waitcnt lgkmcnt(10)
    v_mfma_f32_32x32x16_bf16 a[0:15], v[172:175], v[20:23], a[0:15]
    ds_read_b64_tr_b16 v[144:145], v208 offset:7168
    ds_read_b64_tr_b16 v[146:147], v208 offset:8960
    v_lshlrev_b32 v218, 16, v24
    v_and_b32 v219, 0xffff0000, v24
    v_fma_f32 v218, v218, v216, v217
    v_mfma_f32_32x32x16_bf16 a[16:31], v[176:179], v[20:23], a[16:31]
    ds_read_b64_tr_b16 v[148:149], v209 offset:7232
    ds_read_b64_tr_b16 v[150:151], v209 offset:9024
    v_fma_f32 v219, v219, v216, v217
    v_cvt_pk_bf16_f32 v24, v218, v219
    v_lshlrev_b32 v220, 16, v25
    s_waitcnt lgkmcnt(10)
    v_mfma_f32_32x32x16_bf16 a[32:47], v[180:183], v[20:23], a[32:47]
    ds_read_b64_tr_b16 v[152:153], v208 offset:7296
    ds_read_b64_tr_b16 v[154:155], v208 offset:9088
    v_and_b32 v221, 0xffff0000, v25
    v_fma_f32 v220, v220, v216, v217
    v_fma_f32 v221, v221, v216, v217
    v_mfma_f32_32x32x16_bf16 a[48:63], v[184:187], v[20:23], a[48:63]
    ds_read_b64_tr_b16 v[156:157], v209 offset:7360
    ds_read_b64_tr_b16 v[158:159], v209 offset:9152
    v_cvt_pk_bf16_f32 v25, v220, v221
    v_lshlrev_b32 v218, 16, v26
    v_and_b32 v219, 0xffff0000, v26
    s_waitcnt lgkmcnt(10)
    v_mfma_f32_32x32x16_bf16 a[64:79], v[188:191], v[20:23], a[64:79]
    ds_read_b64_tr_b16 v[160:161], v208 offset:7424
    ds_read_b64_tr_b16 v[162:163], v208 offset:9216
    v_fma_f32 v218, v218, v216, v217
    v_fma_f32 v219, v219, v216, v217
    v_cvt_pk_bf16_f32 v26, v218, v219
    v_mfma_f32_32x32x16_bf16 a[80:95], v[192:195], v[20:23], a[80:95]
    ds_read_b64_tr_b16 v[164:165], v209 offset:7488
    ds_read_b64_tr_b16 v[166:167], v209 offset:9280
    v_lshlrev_b32 v220, 16, v27
    v_and_b32 v221, 0xffff0000, v27
    v_fma_f32 v220, v220, v216, v217
    s_waitcnt lgkmcnt(12)
    v_mfma_f32_32x32x16_bf16 a[96:111], v[196:199], v[20:23], a[96:111]
    ds_read_b64_tr_b16 v[168:169], v208 offset:7552
    ds_read_b64_tr_b16 v[170:171], v208 offset:9344
    v_fma_f32 v221, v221, v216, v217
    v_cvt_pk_bf16_f32 v27, v220, v221
    s_waitcnt lgkmcnt(10)
    v_mfma_f32_32x32x16_bf16 a[0:15], v[144:147], v[24:27], a[0:15]
    ds_read_b64_tr_b16 v[172:173], v208 offset:10752
    ds_read_b64_tr_b16 v[174:175], v208 offset:12544
    v_lshlrev_b32 v218, 16, v28
    v_and_b32 v219, 0xffff0000, v28
    v_fma_f32 v218, v218, v216, v217
    v_fma_f32 v219, v219, v216, v217
    v_cvt_pk_bf16_f32 v28, v218, v219
    v_mfma_f32_32x32x16_bf16 a[16:31], v[148:151], v[24:27], a[16:31]
    ds_read_b64_tr_b16 v[176:177], v209 offset:10816
    ds_read_b64_tr_b16 v[178:179], v209 offset:12608
    v_lshlrev_b32 v220, 16, v29
    v_and_b32 v221, 0xffff0000, v29
    v_fma_f32 v220, v220, v216, v217
    v_fma_f32 v221, v221, v216, v217
    v_cvt_pk_bf16_f32 v29, v220, v221
    s_waitcnt lgkmcnt(10)
    v_mfma_f32_32x32x16_bf16 a[32:47], v[152:155], v[24:27], a[32:47]
    ds_read_b64_tr_b16 v[180:181], v208 offset:10880
    ds_read_b64_tr_b16 v[182:183], v208 offset:12672
    v_lshlrev_b32 v218, 16, v30
    v_and_b32 v219, 0xffff0000, v30
    v_fma_f32 v218, v218, v216, v217
    v_fma_f32 v219, v219, v216, v217
    v_cvt_pk_bf16_f32 v30, v218, v219
    v_mfma_f32_32x32x16_bf16 a[48:63], v[156:159], v[24:27], a[48:63]
    ds_read_b64_tr_b16 v[184:185], v209 offset:10944
    ds_read_b64_tr_b16 v[186:187], v209 offset:12736
    v_lshlrev_b32 v220, 16, v31
    v_and_b32 v221, 0xffff0000, v31
    v_fma_f32 v220, v220, v216, v217
    v_fma_f32 v221, v221, v216, v217
    v_cvt_pk_bf16_f32 v31, v220, v221
    s_waitcnt lgkmcnt(10)
    v_mfma_f32_32x32x16_bf16 a[64:79], v[160:163], v[24:27], a[64:79]
    ds_read_b64_tr_b16 v[188:189], v208 offset:11008
    ds_read_b64_tr_b16 v[190:191], v208 offset:12800
    v_lshlrev_b32 v218, 16, v112
    v_and_b32 v219, 0xffff0000, v112
    v_fma_f32 v218, v218, v216, v217
    v_fma_f32 v219, v219, v216, v217
    v_cvt_pk_bf16_f32 v112, v218, v219
    v_mfma_f32_32x32x16_bf16 a[80:95], v[164:167], v[24:27], a[80:95]
    ds_read_b64_tr_b16 v[192:193], v209 offset:11072
    ds_read_b64_tr_b16 v[194:195], v209 offset:12864
    v_lshlrev_b32 v220, 16, v113
    v_and_b32 v221, 0xffff0000, v113
    v_fma_f32 v220, v220, v216, v217
    v_fma_f32 v221, v221, v216, v217
    v_cvt_pk_bf16_f32 v113, v220, v221
    s_waitcnt lgkmcnt(12)
    v_mfma_f32_32x32x16_bf16 a[96:111], v[168:171], v[24:27], a[96:111]
    ds_read_b64_tr_b16 v[196:197], v208 offset:11136
    ds_read_b64_tr_b16 v[198:199], v208 offset:12928
    s_waitcnt vmcnt(7)
    s_barrier
    s_waitcnt lgkmcnt(10)
    v_mfma_f32_32x32x16_bf16 a[0:15], v[172:175], v[28:31], a[0:15]
    s_add_u32 m0, s30, 57344
    buffer_load_dwordx4 v200, s[16:19], s71 offen lds
    ds_read_b64_tr_b16 v[144:145], v210 offset:0
    ds_read_b64_tr_b16 v[146:147], v210 offset:1792
    v_lshlrev_b32 v218, 16, v32
    v_and_b32 v219, 0xffff0000, v32
    v_fma_f32 v218, v218, v216, v217
    v_fma_f32 v219, v219, v216, v217
    v_cvt_pk_bf16_f32 v32, v218, v219
    v_mfma_f32_32x32x16_bf16 a[16:31], v[176:179], v[28:31], a[16:31]
    ds_read_b64_tr_b16 v[148:149], v211 offset:64
    ds_read_b64_tr_b16 v[150:151], v211 offset:1856
    v_lshlrev_b32 v220, 16, v33
    v_and_b32 v221, 0xffff0000, v33
    v_fma_f32 v220, v220, v216, v217
    v_fma_f32 v221, v221, v216, v217
    v_cvt_pk_bf16_f32 v33, v220, v221
    s_waitcnt lgkmcnt(10)
    v_mfma_f32_32x32x16_bf16 a[32:47], v[180:183], v[28:31], a[32:47]
    ds_read_b64_tr_b16 v[152:153], v210 offset:128
    ds_read_b64_tr_b16 v[154:155], v210 offset:1920
    v_lshlrev_b32 v218, 16, v34
    v_and_b32 v219, 0xffff0000, v34
    v_fma_f32 v218, v218, v216, v217
    v_fma_f32 v219, v219, v216, v217
    v_cvt_pk_bf16_f32 v34, v218, v219
    v_mfma_f32_32x32x16_bf16 a[48:63], v[184:187], v[28:31], a[48:63]
    s_add_u32 m0, s30, 58368
    buffer_load_dwordx4 v201, s[16:19], s71 offen lds
    ds_read_b64_tr_b16 v[156:157], v211 offset:192
    ds_read_b64_tr_b16 v[158:159], v211 offset:1984
    v_lshlrev_b32 v220, 16, v35
    v_and_b32 v221, 0xffff0000, v35
    v_fma_f32 v220, v220, v216, v217
    v_fma_f32 v221, v221, v216, v217
    v_cvt_pk_bf16_f32 v35, v220, v221
    s_waitcnt lgkmcnt(10)
    v_mfma_f32_32x32x16_bf16 a[64:79], v[188:191], v[28:31], a[64:79]
    ds_read_b64_tr_b16 v[160:161], v210 offset:256
    ds_read_b64_tr_b16 v[162:163], v210 offset:2048
    v_lshlrev_b32 v218, 16, v114
    v_and_b32 v219, 0xffff0000, v114
    v_fma_f32 v218, v218, v216, v217
    v_fma_f32 v219, v219, v216, v217
    v_cvt_pk_bf16_f32 v114, v218, v219
    v_mfma_f32_32x32x16_bf16 a[80:95], v[192:195], v[28:31], a[80:95]
    ds_read_b64_tr_b16 v[164:165], v211 offset:320
    ds_read_b64_tr_b16 v[166:167], v211 offset:2112
    v_lshlrev_b32 v220, 16, v115
    v_and_b32 v221, 0xffff0000, v115
    v_fma_f32 v220, v220, v216, v217
    v_fma_f32 v221, v221, v216, v217
    v_cvt_pk_bf16_f32 v115, v220, v221
    s_waitcnt lgkmcnt(12)
    v_mfma_f32_32x32x16_bf16 a[96:111], v[196:199], v[28:31], a[96:111]
    s_add_u32 m0, s30, 59392
    buffer_load_dwordx4 v202, s[16:19], s71 offen lds
    ds_read_b64_tr_b16 v[168:169], v210 offset:384
    ds_read_b64_tr_b16 v[170:171], v210 offset:2176
    s_waitcnt lgkmcnt(10)
    v_mfma_f32_32x32x16_bf16 a[0:15], v[144:147], v[32:35], a[0:15]
    ds_read_b64_tr_b16 v[172:173], v210 offset:3584
    ds_read_b64_tr_b16 v[174:175], v210 offset:5376
    v_lshlrev_b32 v218, 16, v36
    v_and_b32 v219, 0xffff0000, v36
    v_fma_f32 v218, v218, v216, v217
    v_fma_f32 v219, v219, v216, v217
    v_cvt_pk_bf16_f32 v36, v218, v219
    v_mfma_f32_32x32x16_bf16 a[16:31], v[148:151], v[32:35], a[16:31]
    ds_read_b64_tr_b16 v[176:177], v211 offset:3648
    ds_read_b64_tr_b16 v[178:179], v211 offset:5440
    v_lshlrev_b32 v220, 16, v37
    v_and_b32 v221, 0xffff0000, v37
    v_fma_f32 v220, v220, v216, v217
    v_fma_f32 v221, v221, v216, v217
    v_cvt_pk_bf16_f32 v37, v220, v221
    s_waitcnt lgkmcnt(10)
    v_mfma_f32_32x32x16_bf16 a[32:47], v[152:155], v[32:35], a[32:47]
    s_add_u32 m0, s30, 60416
    buffer_load_dwordx4 v203, s[16:19], s71 offen lds
    ds_read_b64_tr_b16 v[180:181], v210 offset:3712
    ds_read_b64_tr_b16 v[182:183], v210 offset:5504
    v_lshlrev_b32 v218, 16, v38
    v_and_b32 v219, 0xffff0000, v38
    v_fma_f32 v218, v218, v216, v217
    v_fma_f32 v219, v219, v216, v217
    v_cvt_pk_bf16_f32 v38, v218, v219
    v_mfma_f32_32x32x16_bf16 a[48:63], v[156:159], v[32:35], a[48:63]
    ds_read_b64_tr_b16 v[184:185], v211 offset:3776
    ds_read_b64_tr_b16 v[186:187], v211 offset:5568
    v_lshlrev_b32 v220, 16, v39
    v_and_b32 v221, 0xffff0000, v39
    v_fma_f32 v220, v220, v216, v217
    v_fma_f32 v221, v221, v216, v217
    v_cvt_pk_bf16_f32 v39, v220, v221
    s_waitcnt lgkmcnt(10)
    v_mfma_f32_32x32x16_bf16 a[64:79], v[160:163], v[32:35], a[64:79]
    ds_read_b64_tr_b16 v[188:189], v210 offset:3840
    ds_read_b64_tr_b16 v[190:191], v210 offset:5632
    v_lshlrev_b32 v218, 16, v116
    v_and_b32 v219, 0xffff0000, v116
    v_fma_f32 v218, v218, v216, v217
    v_fma_f32 v219, v219, v216, v217
    v_cvt_pk_bf16_f32 v116, v218, v219
    v_mfma_f32_32x32x16_bf16 a[80:95], v[164:167], v[32:35], a[80:95]
    s_add_u32 m0, s30, 61440
    buffer_load_dwordx4 v204, s[16:19], s71 offen lds
    ds_read_b64_tr_b16 v[192:193], v211 offset:3904
    ds_read_b64_tr_b16 v[194:195], v211 offset:5696
    v_lshlrev_b32 v220, 16, v117
    v_and_b32 v221, 0xffff0000, v117
    v_fma_f32 v220, v220, v216, v217
    v_fma_f32 v221, v221, v216, v217
    v_cvt_pk_bf16_f32 v117, v220, v221
    s_waitcnt lgkmcnt(12)
    v_mfma_f32_32x32x16_bf16 a[96:111], v[168:171], v[32:35], a[96:111]
    ds_read_b64_tr_b16 v[196:197], v210 offset:3968
    ds_read_b64_tr_b16 v[198:199], v210 offset:5760
    s_waitcnt lgkmcnt(10)
    v_mfma_f32_32x32x16_bf16 a[0:15], v[172:175], v[36:39], a[0:15]
    ds_read_b64_tr_b16 v[144:145], v210 offset:7168
    ds_read_b64_tr_b16 v[146:147], v210 offset:8960
    v_lshlrev_b32 v218, 16, v40
    v_and_b32 v219, 0xffff0000, v40
    v_fma_f32 v218, v218, v216, v217
    v_fma_f32 v219, v219, v216, v217
    v_cvt_pk_bf16_f32 v40, v218, v219
    v_mfma_f32_32x32x16_bf16 a[16:31], v[176:179], v[36:39], a[16:31]
    s_add_u32 m0, s30, 62464
    buffer_load_dwordx4 v205, s[16:19], s71 offen lds
    ds_read_b64_tr_b16 v[148:149], v211 offset:7232
    ds_read_b64_tr_b16 v[150:151], v211 offset:9024
    v_lshlrev_b32 v220, 16, v41
    v_and_b32 v221, 0xffff0000, v41
    v_fma_f32 v220, v220, v216, v217
    v_fma_f32 v221, v221, v216, v217
    v_cvt_pk_bf16_f32 v41, v220, v221
    s_waitcnt lgkmcnt(10)
    v_mfma_f32_32x32x16_bf16 a[32:47], v[180:183], v[36:39], a[32:47]
    ds_read_b64_tr_b16 v[152:153], v210 offset:7296
    ds_read_b64_tr_b16 v[154:155], v210 offset:9088
    v_lshlrev_b32 v218, 16, v42
    v_and_b32 v219, 0xffff0000, v42
    v_fma_f32 v218, v218, v216, v217
    v_fma_f32 v219, v219, v216, v217
    v_cvt_pk_bf16_f32 v42, v218, v219
    v_mfma_f32_32x32x16_bf16 a[48:63], v[184:187], v[36:39], a[48:63]
    ds_read_b64_tr_b16 v[156:157], v211 offset:7360
    ds_read_b64_tr_b16 v[158:159], v211 offset:9152
    v_lshlrev_b32 v220, 16, v43
    v_and_b32 v221, 0xffff0000, v43
    v_fma_f32 v220, v220, v216, v217
    v_fma_f32 v221, v221, v216, v217
    v_cvt_pk_bf16_f32 v43, v220, v221
    s_waitcnt lgkmcnt(10)
    v_mfma_f32_32x32x16_bf16 a[64:79], v[188:191], v[36:39], a[64:79]
    s_add_u32 m0, s30, 63488
    buffer_load_dwordx4 v206, s[16:19], s71 offen lds
    ds_read_b64_tr_b16 v[160:161], v210 offset:7424
    ds_read_b64_tr_b16 v[162:163], v210 offset:9216
    v_lshlrev_b32 v218, 16, v118
    v_and_b32 v219, 0xffff0000, v118
    v_fma_f32 v218, v218, v216, v217
    v_fma_f32 v219, v219, v216, v217
    v_cvt_pk_bf16_f32 v118, v218, v219
    v_mfma_f32_32x32x16_bf16 a[80:95], v[192:195], v[36:39], a[80:95]
    ds_read_b64_tr_b16 v[164:165], v211 offset:7488
    ds_read_b64_tr_b16 v[166:167], v211 offset:9280
    v_lshlrev_b32 v220, 16, v119
    v_and_b32 v221, 0xffff0000, v119
    v_fma_f32 v220, v220, v216, v217
    v_fma_f32 v221, v221, v216, v217
    v_cvt_pk_bf16_f32 v119, v220, v221
    s_waitcnt lgkmcnt(12)
    v_mfma_f32_32x32x16_bf16 a[96:111], v[196:199], v[36:39], a[96:111]
    ds_read_b64_tr_b16 v[168:169], v210 offset:7552
    ds_read_b64_tr_b16 v[170:171], v210 offset:9344
    s_waitcnt lgkmcnt(10)
    v_mfma_f32_32x32x16_bf16 a[0:15], v[144:147], v[40:43], a[0:15]
    ds_read_b64_tr_b16 v[172:173], v210 offset:10752
    ds_read_b64_tr_b16 v[174:175], v210 offset:12544
    v_lshlrev_b32 v218, 16, v44
    v_and_b32 v219, 0xffff0000, v44
    v_fma_f32 v218, v218, v216, v217
    v_fma_f32 v219, v219, v216, v217
    v_cvt_pk_bf16_f32 v44, v218, v219
    v_mfma_f32_32x32x16_bf16 a[16:31], v[148:151], v[40:43], a[16:31]
    ds_read_b64_tr_b16 v[176:177], v211 offset:10816
    ds_read_b64_tr_b16 v[178:179], v211 offset:12608
    v_lshlrev_b32 v220, 16, v45
    v_and_b32 v221, 0xffff0000, v45
    v_fma_f32 v220, v220, v216, v217
    v_fma_f32 v221, v221, v216, v217
    v_cvt_pk_bf16_f32 v45, v220, v221
    s_waitcnt lgkmcnt(10)
    v_mfma_f32_32x32x16_bf16 a[32:47], v[152:155], v[40:43], a[32:47]
    ds_read_b64_tr_b16 v[180:181], v210 offset:10880
    ds_read_b64_tr_b16 v[182:183], v210 offset:12672
    v_lshlrev_b32 v218, 16, v46
    v_and_b32 v219, 0xffff0000, v46
    v_fma_f32 v218, v218, v216, v217
    v_fma_f32 v219, v219, v216, v217
    v_cvt_pk_bf16_f32 v46, v218, v219
    v_mfma_f32_32x32x16_bf16 a[48:63], v[156:159], v[40:43], a[48:63]
    ds_read_b64_tr_b16 v[184:185], v211 offset:10944
    ds_read_b64_tr_b16 v[186:187], v211 offset:12736
    v_lshlrev_b32 v220, 16, v47
    v_and_b32 v221, 0xffff0000, v47
    v_fma_f32 v220, v220, v216, v217
    v_fma_f32 v221, v221, v216, v217
    v_cvt_pk_bf16_f32 v47, v220, v221
    s_waitcnt lgkmcnt(10)
    v_mfma_f32_32x32x16_bf16 a[64:79], v[160:163], v[40:43], a[64:79]
    ds_read_b64_tr_b16 v[188:189], v210 offset:11008
    ds_read_b64_tr_b16 v[190:191], v210 offset:12800
    v_lshlrev_b32 v218, 16, v120
    v_and_b32 v219, 0xffff0000, v120
    v_fma_f32 v218, v218, v216, v217
    v_fma_f32 v219, v219, v216, v217
    v_cvt_pk_bf16_f32 v120, v218, v219
    v_mfma_f32_32x32x16_bf16 a[80:95], v[164:167], v[40:43], a[80:95]
    ds_read_b64_tr_b16 v[192:193], v211 offset:11072
    ds_read_b64_tr_b16 v[194:195], v211 offset:12864
    v_lshlrev_b32 v220, 16, v121
    v_and_b32 v221, 0xffff0000, v121
    v_fma_f32 v220, v220, v216, v217
    v_fma_f32 v221, v221, v216, v217
    v_cvt_pk_bf16_f32 v121, v220, v221
    s_waitcnt lgkmcnt(12)
    v_mfma_f32_32x32x16_bf16 a[96:111], v[168:171], v[40:43], a[96:111]
    ds_read_b64_tr_b16 v[196:197], v210 offset:11136
    ds_read_b64_tr_b16 v[198:199], v210 offset:12928
    s_waitcnt vmcnt(7)
    s_barrier
    s_waitcnt lgkmcnt(10)
    v_mfma_f32_32x32x16_bf16 a[0:15], v[172:175], v[44:47], a[0:15]
    s_add_u32 m0, s30, 133120
    buffer_load_dwordx4 v200, s[16:19], s72 offen lds
    ds_read_b64_tr_b16 v[144:145], v212 offset:0
    ds_read_b64_tr_b16 v[146:147], v212 offset:1792
    v_lshlrev_b32 v218, 16, v48
    v_and_b32 v219, 0xffff0000, v48
    v_fma_f32 v218, v218, v216, v217
    v_fma_f32 v219, v219, v216, v217
    v_cvt_pk_bf16_f32 v48, v218, v219
    v_mfma_f32_32x32x16_bf16 a[16:31], v[176:179], v[44:47], a[16:31]
    ds_read_b64_tr_b16 v[148:149], v213 offset:64
    ds_read_b64_tr_b16 v[150:151], v213 offset:1856
    v_lshlrev_b32 v220, 16, v49
    v_and_b32 v221, 0xffff0000, v49
    v_fma_f32 v220, v220, v216, v217
    v_fma_f32 v221, v221, v216, v217
    v_cvt_pk_bf16_f32 v49, v220, v221
    s_waitcnt lgkmcnt(10)
    v_mfma_f32_32x32x16_bf16 a[32:47], v[180:183], v[44:47], a[32:47]
    ds_read_b64_tr_b16 v[152:153], v212 offset:128
    ds_read_b64_tr_b16 v[154:155], v212 offset:1920
    v_lshlrev_b32 v218, 16, v50
    v_and_b32 v219, 0xffff0000, v50
    v_fma_f32 v218, v218, v216, v217
    v_fma_f32 v219, v219, v216, v217
    v_cvt_pk_bf16_f32 v50, v218, v219
    v_mfma_f32_32x32x16_bf16 a[48:63], v[184:187], v[44:47], a[48:63]
    s_add_u32 m0, s30, 134144
    buffer_load_dwordx4 v201, s[16:19], s72 offen lds
    ds_read_b64_tr_b16 v[156:157], v213 offset:192
    ds_read_b64_tr_b16 v[158:159], v213 offset:1984
    v_lshlrev_b32 v220, 16, v51
    v_and_b32 v221, 0xffff0000, v51
    v_fma_f32 v220, v220, v216, v217
    v_fma_f32 v221, v221, v216, v217
    v_cvt_pk_bf16_f32 v51, v220, v221
    s_waitcnt lgkmcnt(10)
    v_mfma_f32_32x32x16_bf16 a[64:79], v[188:191], v[44:47], a[64:79]
    ds_read_b64_tr_b16 v[160:161], v212 offset:256
    ds_read_b64_tr_b16 v[162:163], v212 offset:2048
    v_lshlrev_b32 v218, 16, v122
    v_and_b32 v219, 0xffff0000, v122
    v_fma_f32 v218, v218, v216, v217
    v_fma_f32 v219, v219, v216, v217
    v_cvt_pk_bf16_f32 v122, v218, v219
    v_mfma_f32_32x32x16_bf16 a[80:95], v[192:195], v[44:47], a[80:95]
    ds_read_b64_tr_b16 v[164:165], v213 offset:320
    ds_read_b64_tr_b16 v[166:167], v213 offset:2112
    v_lshlrev_b32 v220, 16, v123
    v_and_b32 v221, 0xffff0000, v123
    v_fma_f32 v220, v220, v216, v217
    v_fma_f32 v221, v221, v216, v217
    v_cvt_pk_bf16_f32 v123, v220, v221
    s_waitcnt lgkmcnt(12)
    v_mfma_f32_32x32x16_bf16 a[96:111], v[196:199], v[44:47], a[96:111]
    s_add_u32 m0, s30, 135168
    buffer_load_dwordx4 v202, s[16:19], s72 offen lds
    ds_read_b64_tr_b16 v[168:169], v212 offset:384
    ds_read_b64_tr_b16 v[170:171], v212 offset:2176
    s_waitcnt lgkmcnt(10)
    v_mfma_f32_32x32x16_bf16 a[0:15], v[144:147], v[48:51], a[0:15]
    ds_read_b64_tr_b16 v[172:173], v212 offset:3584
    ds_read_b64_tr_b16 v[174:175], v212 offset:5376
    v_lshlrev_b32 v218, 16, v52
    v_and_b32 v219, 0xffff0000, v52
    v_fma_f32 v218, v218, v216, v217
    v_fma_f32 v219, v219, v216, v217
    v_cvt_pk_bf16_f32 v52, v218, v219
    v_mfma_f32_32x32x16_bf16 a[16:31], v[148:151], v[48:51], a[16:31]
    ds_read_b64_tr_b16 v[176:177], v213 offset:3648
    ds_read_b64_tr_b16 v[178:179], v213 offset:5440
    v_lshlrev_b32 v220, 16, v53
    v_and_b32 v221, 0xffff0000, v53
    v_fma_f32 v220, v220, v216, v217
    v_fma_f32 v221, v221, v216, v217
    v_cvt_pk_bf16_f32 v53, v220, v221
    s_waitcnt lgkmcnt(10)
    v_mfma_f32_32x32x16_bf16 a[32:47], v[152:155], v[48:51], a[32:47]
    s_add_u32 m0, s30, 136192
    buffer_load_dwordx4 v203, s[16:19], s72 offen lds
    ds_read_b64_tr_b16 v[180:181], v212 offset:3712
    ds_read_b64_tr_b16 v[182:183], v212 offset:5504
    v_lshlrev_b32 v218, 16, v54
    v_and_b32 v219, 0xffff0000, v54
    v_fma_f32 v218, v218, v216, v217
    v_fma_f32 v219, v219, v216, v217
    v_cvt_pk_bf16_f32 v54, v218, v219
    v_mfma_f32_32x32x16_bf16 a[48:63], v[156:159], v[48:51], a[48:63]
    ds_read_b64_tr_b16 v[184:185], v213 offset:3776
    ds_read_b64_tr_b16 v[186:187], v213 offset:5568
    v_lshlrev_b32 v220, 16, v55
    v_and_b32 v221, 0xffff0000, v55
    v_fma_f32 v220, v220, v216, v217
    v_fma_f32 v221, v221, v216, v217
    v_cvt_pk_bf16_f32 v55, v220, v221
    s_waitcnt lgkmcnt(10)
    v_mfma_f32_32x32x16_bf16 a[64:79], v[160:163], v[48:51], a[64:79]
    ds_read_b64_tr_b16 v[188:189], v212 offset:3840
    ds_read_b64_tr_b16 v[190:191], v212 offset:5632
    v_lshlrev_b32 v218, 16, v124
    v_and_b32 v219, 0xffff0000, v124
    v_fma_f32 v218, v218, v216, v217
    v_fma_f32 v219, v219, v216, v217
    v_cvt_pk_bf16_f32 v124, v218, v219
    v_mfma_f32_32x32x16_bf16 a[80:95], v[164:167], v[48:51], a[80:95]
    s_add_u32 m0, s30, 137216
    buffer_load_dwordx4 v204, s[16:19], s72 offen lds
    ds_read_b64_tr_b16 v[192:193], v213 offset:3904
    ds_read_b64_tr_b16 v[194:195], v213 offset:5696
    v_lshlrev_b32 v220, 16, v125
    v_and_b32 v221, 0xffff0000, v125
    v_fma_f32 v220, v220, v216, v217
    v_fma_f32 v221, v221, v216, v217
    v_cvt_pk_bf16_f32 v125, v220, v221
    s_waitcnt lgkmcnt(12)
    v_mfma_f32_32x32x16_bf16 a[96:111], v[168:171], v[48:51], a[96:111]
    ds_read_b64_tr_b16 v[196:197], v212 offset:3968
    ds_read_b64_tr_b16 v[198:199], v212 offset:5760
    s_waitcnt lgkmcnt(10)
    v_mfma_f32_32x32x16_bf16 a[0:15], v[172:175], v[52:55], a[0:15]
    ds_read_b64_tr_b16 v[144:145], v212 offset:7168
    ds_read_b64_tr_b16 v[146:147], v212 offset:8960
    v_lshlrev_b32 v218, 16, v56
    v_and_b32 v219, 0xffff0000, v56
    v_fma_f32 v218, v218, v216, v217
    v_fma_f32 v219, v219, v216, v217
    v_cvt_pk_bf16_f32 v56, v218, v219
    v_mfma_f32_32x32x16_bf16 a[16:31], v[176:179], v[52:55], a[16:31]
    s_add_u32 m0, s30, 138240
    buffer_load_dwordx4 v205, s[16:19], s72 offen lds
    ds_read_b64_tr_b16 v[148:149], v213 offset:7232
    ds_read_b64_tr_b16 v[150:151], v213 offset:9024
    v_lshlrev_b32 v220, 16, v57
    v_and_b32 v221, 0xffff0000, v57
    v_fma_f32 v220, v220, v216, v217
    v_fma_f32 v221, v221, v216, v217
    v_cvt_pk_bf16_f32 v57, v220, v221
    s_waitcnt lgkmcnt(10)
    v_mfma_f32_32x32x16_bf16 a[32:47], v[180:183], v[52:55], a[32:47]
    ds_read_b64_tr_b16 v[152:153], v212 offset:7296
    ds_read_b64_tr_b16 v[154:155], v212 offset:9088
    v_lshlrev_b32 v218, 16, v58
    v_and_b32 v219, 0xffff0000, v58
    v_fma_f32 v218, v218, v216, v217
    v_fma_f32 v219, v219, v216, v217
    v_cvt_pk_bf16_f32 v58, v218, v219
    v_mfma_f32_32x32x16_bf16 a[48:63], v[184:187], v[52:55], a[48:63]
    ds_read_b64_tr_b16 v[156:157], v213 offset:7360
    ds_read_b64_tr_b16 v[158:159], v213 offset:9152
    v_lshlrev_b32 v220, 16, v59
    v_and_b32 v221, 0xffff0000, v59
    v_fma_f32 v220, v220, v216, v217
    v_fma_f32 v221, v221, v216, v217
    v_cvt_pk_bf16_f32 v59, v220, v221
    s_waitcnt lgkmcnt(10)
    v_mfma_f32_32x32x16_bf16 a[64:79], v[188:191], v[52:55], a[64:79]
    s_add_u32 m0, s30, 139264
    buffer_load_dwordx4 v206, s[16:19], s72 offen lds
    ds_read_b64_tr_b16 v[160:161], v212 offset:7424
    ds_read_b64_tr_b16 v[162:163], v212 offset:9216
    v_lshlrev_b32 v218, 16, v126
    v_and_b32 v219, 0xffff0000, v126
    v_fma_f32 v218, v218, v216, v217
    v_fma_f32 v219, v219, v216, v217
    v_cvt_pk_bf16_f32 v126, v218, v219
    v_mfma_f32_32x32x16_bf16 a[80:95], v[192:195], v[52:55], a[80:95]
    ds_read_b64_tr_b16 v[164:165], v213 offset:7488
    ds_read_b64_tr_b16 v[166:167], v213 offset:9280
    v_lshlrev_b32 v220, 16, v127
    v_and_b32 v221, 0xffff0000, v127
    v_fma_f32 v220, v220, v216, v217
    v_fma_f32 v221, v221, v216, v217
    v_cvt_pk_bf16_f32 v127, v220, v221
    s_waitcnt lgkmcnt(12)
    v_mfma_f32_32x32x16_bf16 a[96:111], v[196:199], v[52:55], a[96:111]
    ds_read_b64_tr_b16 v[168:169], v212 offset:7552
    ds_read_b64_tr_b16 v[170:171], v212 offset:9344
    s_waitcnt lgkmcnt(10)
    v_mfma_f32_32x32x16_bf16 a[0:15], v[144:147], v[56:59], a[0:15]
    ds_read_b64_tr_b16 v[172:173], v212 offset:10752
    ds_read_b64_tr_b16 v[174:175], v212 offset:12544
    v_lshlrev_b32 v218, 16, v60
    v_and_b32 v219, 0xffff0000, v60
    v_fma_f32 v218, v218, v216, v217
    v_fma_f32 v219, v219, v216, v217
    v_cvt_pk_bf16_f32 v60, v218, v219
    v_mfma_f32_32x32x16_bf16 a[16:31], v[148:151], v[56:59], a[16:31]
    ds_read_b64_tr_b16 v[176:177], v213 offset:10816
    ds_read_b64_tr_b16 v[178:179], v213 offset:12608
    v_lshlrev_b32 v220, 16, v61
    v_and_b32 v221, 0xffff0000, v61
    v_fma_f32 v220, v220, v216, v217
    v_fma_f32 v221, v221, v216, v217
    v_cvt_pk_bf16_f32 v61, v220, v221
    s_waitcnt lgkmcnt(10)
    v_mfma_f32_32x32x16_bf16 a[32:47], v[152:155], v[56:59], a[32:47]
    ds_read_b64_tr_b16 v[180:181], v212 offset:10880
    ds_read_b64_tr_b16 v[182:183], v212 offset:12672
    v_lshlrev_b32 v218, 16, v62
    v_and_b32 v219, 0xffff0000, v62
    v_fma_f32 v218, v218, v216, v217
    v_fma_f32 v219, v219, v216, v217
    v_cvt_pk_bf16_f32 v62, v218, v219
    v_mfma_f32_32x32x16_bf16 a[48:63], v[156:159], v[56:59], a[48:63]
    ds_read_b64_tr_b16 v[184:185], v213 offset:10944
    ds_read_b64_tr_b16 v[186:187], v213 offset:12736
    v_lshlrev_b32 v220, 16, v63
    v_and_b32 v221, 0xffff0000, v63
    v_fma_f32 v220, v220, v216, v217
    v_fma_f32 v221, v221, v216, v217
    v_cvt_pk_bf16_f32 v63, v220, v221
    s_waitcnt lgkmcnt(10)
    v_mfma_f32_32x32x16_bf16 a[64:79], v[160:163], v[56:59], a[64:79]
    ds_read_b64_tr_b16 v[188:189], v212 offset:11008
    ds_read_b64_tr_b16 v[190:191], v212 offset:12800
    v_lshlrev_b32 v218, 16, v128
    v_and_b32 v219, 0xffff0000, v128
    v_fma_f32 v218, v218, v216, v217
    v_fma_f32 v219, v219, v216, v217
    v_cvt_pk_bf16_f32 v128, v218, v219
    v_mfma_f32_32x32x16_bf16 a[80:95], v[164:167], v[56:59], a[80:95]
    ds_read_b64_tr_b16 v[192:193], v213 offset:11072
    ds_read_b64_tr_b16 v[194:195], v213 offset:12864
    v_lshlrev_b32 v220, 16, v129
    v_and_b32 v221, 0xffff0000, v129
    v_fma_f32 v220, v220, v216, v217
    v_fma_f32 v221, v221, v216, v217
    v_cvt_pk_bf16_f32 v129, v220, v221
    s_waitcnt lgkmcnt(12)
    v_mfma_f32_32x32x16_bf16 a[96:111], v[168:171], v[56:59], a[96:111]
    ds_read_b64_tr_b16 v[196:197], v212 offset:11136
    ds_read_b64_tr_b16 v[198:199], v212 offset:12928
    s_waitcnt vmcnt(7)
    s_barrier
    s_waitcnt lgkmcnt(10)
    v_mfma_f32_32x32x16_bf16 a[0:15], v[172:175], v[60:63], a[0:15]
    s_add_u32 m0, s30, 0
    buffer_load_dwordx4 v200, s[16:19], s73 offen lds
    ds_read_b64_tr_b16 v[144:145], v214 offset:0
    ds_read_b64_tr_b16 v[146:147], v214 offset:1792
    v_lshlrev_b32 v218, 16, v64
    v_and_b32 v219, 0xffff0000, v64
    v_fma_f32 v218, v218, v216, v217
    v_fma_f32 v219, v219, v216, v217
    v_cvt_pk_bf16_f32 v64, v218, v219
    v_mfma_f32_32x32x16_bf16 a[16:31], v[176:179], v[60:63], a[16:31]
    ds_read_b64_tr_b16 v[148:149], v215 offset:64
    ds_read_b64_tr_b16 v[150:151], v215 offset:1856
    v_lshlrev_b32 v220, 16, v65
    v_and_b32 v221, 0xffff0000, v65
    v_fma_f32 v220, v220, v216, v217
    v_fma_f32 v221, v221, v216, v217
    v_cvt_pk_bf16_f32 v65, v220, v221
    s_waitcnt lgkmcnt(10)
    v_mfma_f32_32x32x16_bf16 a[32:47], v[180:183], v[60:63], a[32:47]
    ds_read_b64_tr_b16 v[152:153], v214 offset:128
    ds_read_b64_tr_b16 v[154:155], v214 offset:1920
    v_lshlrev_b32 v218, 16, v66
    v_and_b32 v219, 0xffff0000, v66
    v_fma_f32 v218, v218, v216, v217
    v_fma_f32 v219, v219, v216, v217
    v_cvt_pk_bf16_f32 v66, v218, v219
    v_mfma_f32_32x32x16_bf16 a[48:63], v[184:187], v[60:63], a[48:63]
    s_add_u32 m0, s30, 1024
    buffer_load_dwordx4 v201, s[16:19], s73 offen lds
    ds_read_b64_tr_b16 v[156:157], v215 offset:192
    ds_read_b64_tr_b16 v[158:159], v215 offset:1984
    v_lshlrev_b32 v220, 16, v67
    v_and_b32 v221, 0xffff0000, v67
    v_fma_f32 v220, v220, v216, v217
    v_fma_f32 v221, v221, v216, v217
    v_cvt_pk_bf16_f32 v67, v220, v221
    s_waitcnt lgkmcnt(10)
    v_mfma_f32_32x32x16_bf16 a[64:79], v[188:191], v[60:63], a[64:79]
    ds_read_b64_tr_b16 v[160:161], v214 offset:256
    ds_read_b64_tr_b16 v[162:163], v214 offset:2048
    v_lshlrev_b32 v218, 16, v130
    v_and_b32 v219, 0xffff0000, v130
    v_fma_f32 v218, v218, v216, v217
    v_fma_f32 v219, v219, v216, v217
    v_cvt_pk_bf16_f32 v130, v218, v219
    v_mfma_f32_32x32x16_bf16 a[80:95], v[192:195], v[60:63], a[80:95]
    ds_read_b64_tr_b16 v[164:165], v215 offset:320
    ds_read_b64_tr_b16 v[166:167], v215 offset:2112
    v_lshlrev_b32 v220, 16, v131
    v_and_b32 v221, 0xffff0000, v131
    v_fma_f32 v220, v220, v216, v217
    v_fma_f32 v221, v221, v216, v217
    v_cvt_pk_bf16_f32 v131, v220, v221
    s_waitcnt lgkmcnt(12)
    v_mfma_f32_32x32x16_bf16 a[96:111], v[196:199], v[60:63], a[96:111]
    s_add_u32 m0, s30, 2048
    buffer_load_dwordx4 v202, s[16:19], s73 offen lds
    ds_read_b64_tr_b16 v[168:169], v214 offset:384
    ds_read_b64_tr_b16 v[170:171], v214 offset:2176
    s_waitcnt lgkmcnt(10)
    v_mfma_f32_32x32x16_bf16 a[0:15], v[144:147], v[64:67], a[0:15]
    ds_read_b64_tr_b16 v[172:173], v214 offset:3584
    ds_read_b64_tr_b16 v[174:175], v214 offset:5376
    v_lshlrev_b32 v218, 16, v68
    v_and_b32 v219, 0xffff0000, v68
    v_fma_f32 v218, v218, v216, v217
    v_fma_f32 v219, v219, v216, v217
    v_cvt_pk_bf16_f32 v68, v218, v219
    v_mfma_f32_32x32x16_bf16 a[16:31], v[148:151], v[64:67], a[16:31]
    ds_read_b64_tr_b16 v[176:177], v215 offset:3648
    ds_read_b64_tr_b16 v[178:179], v215 offset:5440
    v_lshlrev_b32 v220, 16, v69
    v_and_b32 v221, 0xffff0000, v69
    v_fma_f32 v220, v220, v216, v217
    v_fma_f32 v221, v221, v216, v217
    v_cvt_pk_bf16_f32 v69, v220, v221
    s_waitcnt lgkmcnt(10)
    v_mfma_f32_32x32x16_bf16 a[32:47], v[152:155], v[64:67], a[32:47]
    s_add_u32 m0, s30, 3072
    buffer_load_dwordx4 v203, s[16:19], s73 offen lds
    ds_read_b64_tr_b16 v[180:181], v214 offset:3712
    ds_read_b64_tr_b16 v[182:183], v214 offset:5504
    v_lshlrev_b32 v218, 16, v70
    v_and_b32 v219, 0xffff0000, v70
    v_fma_f32 v218, v218, v216, v217
    v_fma_f32 v219, v219, v216, v217
    v_cvt_pk_bf16_f32 v70, v218, v219
    v_mfma_f32_32x32x16_bf16 a[48:63], v[156:159], v[64:67], a[48:63]
    ds_read_b64_tr_b16 v[184:185], v215 offset:3776
    ds_read_b64_tr_b16 v[186:187], v215 offset:5568
    v_lshlrev_b32 v220, 16, v71
    v_and_b32 v221, 0xffff0000, v71
    v_fma_f32 v220, v220, v216, v217
    v_fma_f32 v221, v221, v216, v217
    v_cvt_pk_bf16_f32 v71, v220, v221
    s_waitcnt lgkmcnt(10)
    v_mfma_f32_32x32x16_bf16 a[64:79], v[160:163], v[64:67], a[64:79]
    ds_read_b64_tr_b16 v[188:189], v214 offset:3840
    ds_read_b64_tr_b16 v[190:191], v214 offset:5632
    v_lshlrev_b32 v218, 16, v132
    v_and_b32 v219, 0xffff0000, v132
    v_fma_f32 v218, v218, v216, v217
    v_fma_f32 v219, v219, v216, v217
    v_cvt_pk_bf16_f32 v132, v218, v219
    v_mfma_f32_32x32x16_bf16 a[80:95], v[164:167], v[64:67], a[80:95]
    s_add_u32 m0, s30, 4096
    buffer_load_dwordx4 v204, s[16:19], s73 offen lds
    ds_read_b64_tr_b16 v[192:193], v215 offset:3904
    ds_read_b64_tr_b16 v[194:195], v215 offset:5696
    v_lshlrev_b32 v220, 16, v133
    v_and_b32 v221, 0xffff0000, v133
    v_fma_f32 v220, v220, v216, v217
    v_fma_f32 v221, v221, v216, v217
    v_cvt_pk_bf16_f32 v133, v220, v221
    s_waitcnt lgkmcnt(12)
    v_mfma_f32_32x32x16_bf16 a[96:111], v[168:171], v[64:67], a[96:111]
    ds_read_b64_tr_b16 v[196:197], v214 offset:3968
    ds_read_b64_tr_b16 v[198:199], v214 offset:5760
    s_waitcnt lgkmcnt(10)
    v_mfma_f32_32x32x16_bf16 a[0:15], v[172:175], v[68:71], a[0:15]
    ds_read_b64_tr_b16 v[144:145], v214 offset:7168
    ds_read_b64_tr_b16 v[146:147], v214 offset:8960
    v_lshlrev_b32 v218, 16, v72
    v_and_b32 v219, 0xffff0000, v72
    v_fma_f32 v218, v218, v216, v217
    v_fma_f32 v219, v219, v216, v217
    v_cvt_pk_bf16_f32 v72, v218, v219
    v_mfma_f32_32x32x16_bf16 a[16:31], v[176:179], v[68:71], a[16:31]
    s_add_u32 m0, s30, 5120
    buffer_load_dwordx4 v205, s[16:19], s73 offen lds
    ds_read_b64_tr_b16 v[148:149], v215 offset:7232
    ds_read_b64_tr_b16 v[150:151], v215 offset:9024
    v_lshlrev_b32 v220, 16, v73
    v_and_b32 v221, 0xffff0000, v73
    v_fma_f32 v220, v220, v216, v217
    v_fma_f32 v221, v221, v216, v217
    v_cvt_pk_bf16_f32 v73, v220, v221
    s_waitcnt lgkmcnt(10)
    v_mfma_f32_32x32x16_bf16 a[32:47], v[180:183], v[68:71], a[32:47]
    ds_read_b64_tr_b16 v[152:153], v214 offset:7296
    ds_read_b64_tr_b16 v[154:155], v214 offset:9088
    v_lshlrev_b32 v218, 16, v74
    v_and_b32 v219, 0xffff0000, v74
    v_fma_f32 v218, v218, v216, v217
    v_fma_f32 v219, v219, v216, v217
    v_cvt_pk_bf16_f32 v74, v218, v219
    v_mfma_f32_32x32x16_bf16 a[48:63], v[184:187], v[68:71], a[48:63]
    ds_read_b64_tr_b16 v[156:157], v215 offset:7360
    ds_read_b64_tr_b16 v[158:159], v215 offset:9152
    v_lshlrev_b32 v220, 16, v75
    v_and_b32 v221, 0xffff0000, v75
    v_fma_f32 v220, v220, v216, v217
    v_fma_f32 v221, v221, v216, v217
    v_cvt_pk_bf16_f32 v75, v220, v221
    s_waitcnt lgkmcnt(10)
    v_mfma_f32_32x32x16_bf16 a[64:79], v[188:191], v[68:71], a[64:79]
    s_add_u32 m0, s30, 6144
    buffer_load_dwordx4 v206, s[16:19], s73 offen lds
    ds_read_b64_tr_b16 v[160:161], v214 offset:7424
    ds_read_b64_tr_b16 v[162:163], v214 offset:9216
    v_lshlrev_b32 v218, 16, v134
    v_and_b32 v219, 0xffff0000, v134
    v_fma_f32 v218, v218, v216, v217
    v_fma_f32 v219, v219, v216, v217
    v_cvt_pk_bf16_f32 v134, v218, v219
    v_mfma_f32_32x32x16_bf16 a[80:95], v[192:195], v[68:71], a[80:95]
    ds_read_b64_tr_b16 v[164:165], v215 offset:7488
    ds_read_b64_tr_b16 v[166:167], v215 offset:9280
    v_lshlrev_b32 v220, 16, v135
    v_and_b32 v221, 0xffff0000, v135
    v_fma_f32 v220, v220, v216, v217
    v_fma_f32 v221, v221, v216, v217
    v_cvt_pk_bf16_f32 v135, v220, v221
    s_waitcnt lgkmcnt(12)
    v_mfma_f32_32x32x16_bf16 a[96:111], v[196:199], v[68:71], a[96:111]
    ds_read_b64_tr_b16 v[168:169], v214 offset:7552
    ds_read_b64_tr_b16 v[170:171], v214 offset:9344
    s_waitcnt lgkmcnt(10)
    v_mfma_f32_32x32x16_bf16 a[0:15], v[144:147], v[72:75], a[0:15]
    ds_read_b64_tr_b16 v[172:173], v214 offset:10752
    ds_read_b64_tr_b16 v[174:175], v214 offset:12544
    v_lshlrev_b32 v218, 16, v76
    v_and_b32 v219, 0xffff0000, v76
    v_fma_f32 v218, v218, v216, v217
    v_fma_f32 v219, v219, v216, v217
    v_cvt_pk_bf16_f32 v76, v218, v219
    v_mfma_f32_32x32x16_bf16 a[16:31], v[148:151], v[72:75], a[16:31]
    ds_read_b64_tr_b16 v[176:177], v215 offset:10816
    ds_read_b64_tr_b16 v[178:179], v215 offset:12608
    v_lshlrev_b32 v220, 16, v77
    v_and_b32 v221, 0xffff0000, v77
    v_fma_f32 v220, v220, v216, v217
    v_fma_f32 v221, v221, v216, v217
    v_cvt_pk_bf16_f32 v77, v220, v221
    s_waitcnt lgkmcnt(10)
    v_mfma_f32_32x32x16_bf16 a[32:47], v[152:155], v[72:75], a[32:47]
    ds_read_b64_tr_b16 v[180:181], v214 offset:10880
    ds_read_b64_tr_b16 v[182:183], v214 offset:12672
    v_lshlrev_b32 v218, 16, v78
    v_and_b32 v219, 0xffff0000, v78
    v_fma_f32 v218, v218, v216, v217
    v_fma_f32 v219, v219, v216, v217
    v_cvt_pk_bf16_f32 v78, v218, v219
    v_mfma_f32_32x32x16_bf16 a[48:63], v[156:159], v[72:75], a[48:63]
    ds_read_b64_tr_b16 v[184:185], v215 offset:10944
    ds_read_b64_tr_b16 v[186:187], v215 offset:12736
    v_lshlrev_b32 v220, 16, v79
    v_and_b32 v221, 0xffff0000, v79
    v_fma_f32 v220, v220, v216, v217
    v_fma_f32 v221, v221, v216, v217
    v_cvt_pk_bf16_f32 v79, v220, v221
    s_waitcnt lgkmcnt(10)
    v_mfma_f32_32x32x16_bf16 a[64:79], v[160:163], v[72:75], a[64:79]
    ds_read_b64_tr_b16 v[188:189], v214 offset:11008
    ds_read_b64_tr_b16 v[190:191], v214 offset:12800
    v_lshlrev_b32 v218, 16, v136
    v_and_b32 v219, 0xffff0000, v136
    v_fma_f32 v218, v218, v216, v217
    v_fma_f32 v219, v219, v216, v217
    v_cvt_pk_bf16_f32 v136, v218, v219
    v_mfma_f32_32x32x16_bf16 a[80:95], v[164:167], v[72:75], a[80:95]
    ds_read_b64_tr_b16 v[192:193], v215 offset:11072
    ds_read_b64_tr_b16 v[194:195], v215 offset:12864
    v_lshlrev_b32 v220, 16, v137
    v_and_b32 v221, 0xffff0000, v137
    v_fma_f32 v220, v220, v216, v217
    v_fma_f32 v221, v221, v216, v217
    v_cvt_pk_bf16_f32 v137, v220, v221
    s_waitcnt lgkmcnt(12)
    v_mfma_f32_32x32x16_bf16 a[96:111], v[168:171], v[72:75], a[96:111]
    ds_read_b64_tr_b16 v[196:197], v214 offset:11136
    ds_read_b64_tr_b16 v[198:199], v214 offset:12928
    s_waitcnt vmcnt(7)
    s_barrier
    s_waitcnt lgkmcnt(10)
    v_mfma_f32_32x32x16_bf16 a[0:15], v[172:175], v[76:79], a[0:15]
    s_add_u32 m0, s30, 28672
    buffer_load_dwordx4 v200, s[16:19], s74 offen lds
    ds_read_b64_tr_b16 v[144:145], v208 offset:0
    ds_read_b64_tr_b16 v[146:147], v208 offset:1792
    v_lshlrev_b32 v218, 16, v80
    v_and_b32 v219, 0xffff0000, v80
    v_fma_f32 v218, v218, v216, v217
    v_fma_f32 v219, v219, v216, v217
    v_cvt_pk_bf16_f32 v80, v218, v219
    v_mfma_f32_32x32x16_bf16 a[16:31], v[176:179], v[76:79], a[16:31]
    ds_read_b64_tr_b16 v[148:149], v209 offset:64
    ds_read_b64_tr_b16 v[150:151], v209 offset:1856
    v_lshlrev_b32 v220, 16, v81
    v_and_b32 v221, 0xffff0000, v81
    v_fma_f32 v220, v220, v216, v217
    v_fma_f32 v221, v221, v216, v217
    v_cvt_pk_bf16_f32 v81, v220, v221
    s_waitcnt lgkmcnt(10)
    v_mfma_f32_32x32x16_bf16 a[32:47], v[180:183], v[76:79], a[32:47]
    s_add_u32 m0, s30, 29696
    buffer_load_dwordx4 v201, s[16:19], s74 offen lds
    ds_read_b64_tr_b16 v[152:153], v208 offset:128
    ds_read_b64_tr_b16 v[154:155], v208 offset:1920
    v_lshlrev_b32 v218, 16, v82
    v_and_b32 v219, 0xffff0000, v82
    v_fma_f32 v218, v218, v216, v217
    v_fma_f32 v219, v219, v216, v217
    v_cvt_pk_bf16_f32 v82, v218, v219
    v_mfma_f32_32x32x16_bf16 a[48:63], v[184:187], v[76:79], a[48:63]
    ds_read_b64_tr_b16 v[156:157], v209 offset:192
    ds_read_b64_tr_b16 v[158:159], v209 offset:1984
    v_lshlrev_b32 v220, 16, v83
    v_and_b32 v221, 0xffff0000, v83
    v_fma_f32 v220, v220, v216, v217
    v_fma_f32 v221, v221, v216, v217
    v_cvt_pk_bf16_f32 v83, v220, v221
    s_waitcnt lgkmcnt(10)
    v_mfma_f32_32x32x16_bf16 a[64:79], v[188:191], v[76:79], a[64:79]
    s_add_u32 m0, s30, 30720
    buffer_load_dwordx4 v202, s[16:19], s74 offen lds
    ds_read_b64_tr_b16 v[160:161], v208 offset:256
    ds_read_b64_tr_b16 v[162:163], v208 offset:2048
    v_lshlrev_b32 v218, 16, v138
    v_and_b32 v219, 0xffff0000, v138
    v_fma_f32 v218, v218, v216, v217
    v_fma_f32 v219, v219, v216, v217
    v_cvt_pk_bf16_f32 v138, v218, v219
    v_mfma_f32_32x32x16_bf16 a[80:95], v[192:195], v[76:79], a[80:95]
    ds_read_b64_tr_b16 v[164:165], v209 offset:320
    ds_read_b64_tr_b16 v[166:167], v209 offset:2112
    v_lshlrev_b32 v220, 16, v139
    v_and_b32 v221, 0xffff0000, v139
    v_fma_f32 v220, v220, v216, v217
    v_fma_f32 v221, v221, v216, v217
    v_cvt_pk_bf16_f32 v139, v220, v221
    s_waitcnt lgkmcnt(12)
    v_mfma_f32_32x32x16_bf16 a[96:111], v[196:199], v[76:79], a[96:111]
    s_add_u32 m0, s30, 31744
    buffer_load_dwordx4 v203, s[16:19], s74 offen lds
    ds_read_b64_tr_b16 v[168:169], v208 offset:384
    ds_read_b64_tr_b16 v[170:171], v208 offset:2176
    s_waitcnt lgkmcnt(10)
    v_mfma_f32_32x32x16_bf16 a[0:15], v[144:147], v[80:83], a[0:15]
    ds_read_b64_tr_b16 v[172:173], v208 offset:3584
    ds_read_b64_tr_b16 v[174:175], v208 offset:5376
    v_lshlrev_b32 v218, 16, v84
    v_and_b32 v219, 0xffff0000, v84
    v_fma_f32 v218, v218, v216, v217
    v_fma_f32 v219, v219, v216, v217
    v_cvt_pk_bf16_f32 v84, v218, v219
    v_mfma_f32_32x32x16_bf16 a[16:31], v[148:151], v[80:83], a[16:31]
    s_add_u32 m0, s30, 32768
    buffer_load_dwordx4 v204, s[16:19], s74 offen lds
    ds_read_b64_tr_b16 v[176:177], v209 offset:3648
    ds_read_b64_tr_b16 v[178:179], v209 offset:5440
    v_lshlrev_b32 v220, 16, v85
    v_and_b32 v221, 0xffff0000, v85
    v_fma_f32 v220, v220, v216, v217
    v_fma_f32 v221, v221, v216, v217
    v_cvt_pk_bf16_f32 v85, v220, v221
    s_waitcnt lgkmcnt(10)
    v_mfma_f32_32x32x16_bf16 a[32:47], v[152:155], v[80:83], a[32:47]
    ds_read_b64_tr_b16 v[180:181], v208 offset:3712
    ds_read_b64_tr_b16 v[182:183], v208 offset:5504
    v_lshlrev_b32 v218, 16, v86
    v_and_b32 v219, 0xffff0000, v86
    v_fma_f32 v218, v218, v216, v217
    v_fma_f32 v219, v219, v216, v217
    v_cvt_pk_bf16_f32 v86, v218, v219
    v_mfma_f32_32x32x16_bf16 a[48:63], v[156:159], v[80:83], a[48:63]
    s_add_u32 m0, s30, 33792
    buffer_load_dwordx4 v205, s[16:19], s74 offen lds
    ds_read_b64_tr_b16 v[184:185], v209 offset:3776
    ds_read_b64_tr_b16 v[186:187], v209 offset:5568
    v_lshlrev_b32 v220, 16, v87
    v_and_b32 v221, 0xffff0000, v87
    v_fma_f32 v220, v220, v216, v217
    v_fma_f32 v221, v221, v216, v217
    v_cvt_pk_bf16_f32 v87, v220, v221
    s_waitcnt lgkmcnt(10)
    v_mfma_f32_32x32x16_bf16 a[64:79], v[160:163], v[80:83], a[64:79]
    ds_read_b64_tr_b16 v[188:189], v208 offset:3840
    ds_read_b64_tr_b16 v[190:191], v208 offset:5632
    v_lshlrev_b32 v218, 16, v140
    v_and_b32 v219, 0xffff0000, v140
    v_fma_f32 v218, v218, v216, v217
    v_fma_f32 v219, v219, v216, v217
    v_cvt_pk_bf16_f32 v140, v218, v219
    v_mfma_f32_32x32x16_bf16 a[80:95], v[164:167], v[80:83], a[80:95]
    s_add_u32 m0, s30, 34816
    buffer_load_dwordx4 v206, s[16:19], s74 offen lds
    ds_read_b64_tr_b16 v[192:193], v209 offset:3904
    ds_read_b64_tr_b16 v[194:195], v209 offset:5696
    v_lshlrev_b32 v220, 16, v141
    v_and_b32 v221, 0xffff0000, v141
    v_fma_f32 v220, v220, v216, v217
    v_fma_f32 v221, v221, v216, v217
    v_cvt_pk_bf16_f32 v141, v220, v221
    s_waitcnt lgkmcnt(12)
    v_mfma_f32_32x32x16_bf16 a[96:111], v[168:171], v[80:83], a[96:111]
    ds_read_b64_tr_b16 v[196:197], v208 offset:3968
    ds_read_b64_tr_b16 v[198:199], v208 offset:5760
    s_waitcnt lgkmcnt(10)
    v_mfma_f32_32x32x16_bf16 a[0:15], v[172:175], v[84:87], a[0:15]
    s_add_u32 m0, s30, 57344
    buffer_load_dwordx4 v200, s[16:19], s75 offen lds
    ds_read_b64_tr_b16 v[144:145], v208 offset:7168
    ds_read_b64_tr_b16 v[146:147], v208 offset:8960
    v_lshlrev_b32 v218, 16, v88
    v_and_b32 v219, 0xffff0000, v88
    v_fma_f32 v218, v218, v216, v217
    v_fma_f32 v219, v219, v216, v217
    v_cvt_pk_bf16_f32 v88, v218, v219
    v_mfma_f32_32x32x16_bf16 a[16:31], v[176:179], v[84:87], a[16:31]
    ds_read_b64_tr_b16 v[148:149], v209 offset:7232
    ds_read_b64_tr_b16 v[150:151], v209 offset:9024
    v_lshlrev_b32 v220, 16, v89
    v_and_b32 v221, 0xffff0000, v89
    v_fma_f32 v220, v220, v216, v217
    v_fma_f32 v221, v221, v216, v217
    v_cvt_pk_bf16_f32 v89, v220, v221
    s_waitcnt lgkmcnt(10)
    v_mfma_f32_32x32x16_bf16 a[32:47], v[180:183], v[84:87], a[32:47]
    s_add_u32 m0, s30, 58368
    buffer_load_dwordx4 v201, s[16:19], s75 offen lds
    ds_read_b64_tr_b16 v[152:153], v208 offset:7296
    ds_read_b64_tr_b16 v[154:155], v208 offset:9088
    v_lshlrev_b32 v218, 16, v90
    v_and_b32 v219, 0xffff0000, v90
    v_fma_f32 v218, v218, v216, v217
    v_fma_f32 v219, v219, v216, v217
    v_cvt_pk_bf16_f32 v90, v218, v219
    v_mfma_f32_32x32x16_bf16 a[48:63], v[184:187], v[84:87], a[48:63]
    ds_read_b64_tr_b16 v[156:157], v209 offset:7360
    ds_read_b64_tr_b16 v[158:159], v209 offset:9152
    v_lshlrev_b32 v220, 16, v91
    v_and_b32 v221, 0xffff0000, v91
    v_fma_f32 v220, v220, v216, v217
    v_fma_f32 v221, v221, v216, v217
    v_cvt_pk_bf16_f32 v91, v220, v221
    s_waitcnt lgkmcnt(10)
    v_mfma_f32_32x32x16_bf16 a[64:79], v[188:191], v[84:87], a[64:79]
    s_add_u32 m0, s30, 59392
    buffer_load_dwordx4 v202, s[16:19], s75 offen lds
    ds_read_b64_tr_b16 v[160:161], v208 offset:7424
    ds_read_b64_tr_b16 v[162:163], v208 offset:9216
    v_lshlrev_b32 v218, 16, v142
    v_and_b32 v219, 0xffff0000, v142
    v_fma_f32 v218, v218, v216, v217
    v_fma_f32 v219, v219, v216, v217
    v_cvt_pk_bf16_f32 v142, v218, v219
    v_mfma_f32_32x32x16_bf16 a[80:95], v[192:195], v[84:87], a[80:95]
    ds_read_b64_tr_b16 v[164:165], v209 offset:7488
    ds_read_b64_tr_b16 v[166:167], v209 offset:9280
    v_lshlrev_b32 v220, 16, v143
    v_and_b32 v221, 0xffff0000, v143
    v_fma_f32 v220, v220, v216, v217
    v_fma_f32 v221, v221, v216, v217
    v_cvt_pk_bf16_f32 v143, v220, v221
    s_waitcnt lgkmcnt(12)
    v_mfma_f32_32x32x16_bf16 a[96:111], v[196:199], v[84:87], a[96:111]
    s_add_u32 m0, s30, 60416
    buffer_load_dwordx4 v203, s[16:19], s75 offen lds
    ds_read_b64_tr_b16 v[168:169], v208 offset:7552
    ds_read_b64_tr_b16 v[170:171], v208 offset:9344
    s_waitcnt lgkmcnt(10)
    v_mfma_f32_32x32x16_bf16 a[0:15], v[144:147], v[88:91], a[0:15]
    ds_read_b64_tr_b16 v[172:173], v208 offset:10752
    ds_read_b64_tr_b16 v[174:175], v208 offset:12544
    v_lshlrev_b32 v218, 16, v92
    v_and_b32 v219, 0xffff0000, v92
    v_fma_f32 v218, v218, v216, v217
    v_mfma_f32_32x32x16_bf16 a[16:31], v[148:151], v[88:91], a[16:31]
    s_add_u32 m0, s30, 61440
    buffer_load_dwordx4 v204, s[16:19], s75 offen lds
    ds_read_b64_tr_b16 v[176:177], v209 offset:10816
    ds_read_b64_tr_b16 v[178:179], v209 offset:12608
    v_fma_f32 v219, v219, v216, v217
    v_cvt_pk_bf16_f32 v92, v218, v219
    v_lshlrev_b32 v220, 16, v93
    s_waitcnt lgkmcnt(10)
    v_mfma_f32_32x32x16_bf16 a[32:47], v[152:155], v[88:91], a[32:47]
    ds_read_b64_tr_b16 v[180:181], v208 offset:10880
    ds_read_b64_tr_b16 v[182:183], v208 offset:12672
    v_and_b32 v221, 0xffff0000, v93
    v_fma_f32 v220, v220, v216, v217
    v_fma_f32 v221, v221, v216, v217
    v_mfma_f32_32x32x16_bf16 a[48:63], v[156:159], v[88:91], a[48:63]
    s_add_u32 m0, s30, 62464
    buffer_load_dwordx4 v205, s[16:19], s75 offen lds
    ds_read_b64_tr_b16 v[184:185], v209 offset:10944
    ds_read_b64_tr_b16 v[186:187], v209 offset:12736
    v_cvt_pk_bf16_f32 v93, v220, v221
    v_lshlrev_b32 v218, 16, v94
    v_and_b32 v219, 0xffff0000, v94
    s_waitcnt lgkmcnt(10)
    v_mfma_f32_32x32x16_bf16 a[64:79], v[160:163], v[88:91], a[64:79]
    ds_read_b64_tr_b16 v[188:189], v208 offset:11008
    ds_read_b64_tr_b16 v[190:191], v208 offset:12800
    v_fma_f32 v218, v218, v216, v217
    v_fma_f32 v219, v219, v216, v217
    v_cvt_pk_bf16_f32 v94, v218, v219
    v_mfma_f32_32x32x16_bf16 a[80:95], v[164:167], v[88:91], a[80:95]
    s_add_u32 m0, s30, 63488
    buffer_load_dwordx4 v206, s[16:19], s75 offen lds
    ds_read_b64_tr_b16 v[192:193], v209 offset:11072
    ds_read_b64_tr_b16 v[194:195], v209 offset:12864
    v_lshlrev_b32 v220, 16, v95
    v_and_b32 v221, 0xffff0000, v95
    v_fma_f32 v220, v220, v216, v217
    s_waitcnt lgkmcnt(12)
    v_mfma_f32_32x32x16_bf16 a[96:111], v[168:171], v[88:91], a[96:111]
    ds_read_b64_tr_b16 v[196:197], v208 offset:11136
    ds_read_b64_tr_b16 v[198:199], v208 offset:12928
    v_fma_f32 v221, v221, v216, v217
    v_cvt_pk_bf16_f32 v95, v220, v221
    s_waitcnt vmcnt(14)
    s_barrier
    s_waitcnt lgkmcnt(10)
    v_mfma_f32_32x32x16_bf16 a[0:15], v[172:175], v[92:95], a[0:15]
    ds_read_b64_tr_b16 v[144:145], v210 offset:0
    ds_read_b64_tr_b16 v[146:147], v210 offset:1792
    v_lshlrev_b32 v218, 16, v96
    v_and_b32 v219, 0xffff0000, v96
    v_fma_f32 v218, v218, v216, v217
    v_mfma_f32_32x32x16_bf16 a[16:31], v[176:179], v[92:95], a[16:31]
    ds_read_b64_tr_b16 v[148:149], v211 offset:64
    ds_read_b64_tr_b16 v[150:151], v211 offset:1856
    v_fma_f32 v219, v219, v216, v217
    v_cvt_pk_bf16_f32 v96, v218, v219
    v_lshlrev_b32 v220, 16, v97
    s_waitcnt lgkmcnt(10)
    v_mfma_f32_32x32x16_bf16 a[32:47], v[180:183], v[92:95], a[32:47]
    ds_read_b64_tr_b16 v[152:153], v210 offset:128
    ds_read_b64_tr_b16 v[154:155], v210 offset:1920
    v_and_b32 v221, 0xffff0000, v97
    v_fma_f32 v220, v220, v216, v217
    v_fma_f32 v221, v221, v216, v217
    v_mfma_f32_32x32x16_bf16 a[48:63], v[184:187], v[92:95], a[48:63]
    ds_read_b64_tr_b16 v[156:157], v211 offset:192
    ds_read_b64_tr_b16 v[158:159], v211 offset:1984
    v_cvt_pk_bf16_f32 v97, v220, v221
    v_lshlrev_b32 v218, 16, v98
    v_and_b32 v219, 0xffff0000, v98
    s_waitcnt lgkmcnt(10)
    v_mfma_f32_32x32x16_bf16 a[64:79], v[188:191], v[92:95], a[64:79]
    ds_read_b64_tr_b16 v[160:161], v210 offset:256
    ds_read_b64_tr_b16 v[162:163], v210 offset:2048
    v_fma_f32 v218, v218, v216, v217
    v_fma_f32 v219, v219, v216, v217
    v_cvt_pk_bf16_f32 v98, v218, v219
    v_mfma_f32_32x32x16_bf16 a[80:95], v[192:195], v[92:95], a[80:95]
    ds_read_b64_tr_b16 v[164:165], v211 offset:320
    ds_read_b64_tr_b16 v[166:167], v211 offset:2112
    v_lshlrev_b32 v220, 16, v99
    v_and_b32 v221, 0xffff0000, v99
    v_fma_f32 v220, v220, v216, v217
    s_waitcnt lgkmcnt(12)
    v_mfma_f32_32x32x16_bf16 a[96:111], v[196:199], v[92:95], a[96:111]
    ds_read_b64_tr_b16 v[168:169], v210 offset:384
    ds_read_b64_tr_b16 v[170:171], v210 offset:2176
    v_fma_f32 v221, v221, v216, v217
    v_cvt_pk_bf16_f32 v99, v220, v221
    s_waitcnt lgkmcnt(10)
    v_mfma_f32_32x32x16_bf16 a[0:15], v[144:147], v[96:99], a[0:15]
    ds_read_b64_tr_b16 v[172:173], v210 offset:3584
    ds_read_b64_tr_b16 v[174:175], v210 offset:5376
    v_lshlrev_b32 v218, 16, v100
    v_and_b32 v219, 0xffff0000, v100
    v_fma_f32 v218, v218, v216, v217
    v_mfma_f32_32x32x16_bf16 a[16:31], v[148:151], v[96:99], a[16:31]
    ds_read_b64_tr_b16 v[176:177], v211 offset:3648
    ds_read_b64_tr_b16 v[178:179], v211 offset:5440
    v_fma_f32 v219, v219, v216, v217
    v_cvt_pk_bf16_f32 v100, v218, v219
    v_lshlrev_b32 v220, 16, v101
    s_waitcnt lgkmcnt(10)
    v_mfma_f32_32x32x16_bf16 a[32:47], v[152:155], v[96:99], a[32:47]
    ds_read_b64_tr_b16 v[180:181], v210 offset:3712
    ds_read_b64_tr_b16 v[182:183], v210 offset:5504
    v_and_b32 v221, 0xffff0000, v101
    v_fma_f32 v220, v220, v216, v217
    v_fma_f32 v221, v221, v216, v217
    v_mfma_f32_32x32x16_bf16 a[48:63], v[156:159], v[96:99], a[48:63]
    ds_read_b64_tr_b16 v[184:185], v211 offset:3776
    ds_read_b64_tr_b16 v[186:187], v211 offset:5568
    v_cvt_pk_bf16_f32 v101, v220, v221
    v_lshlrev_b32 v218, 16, v102
    v_and_b32 v219, 0xffff0000, v102
    s_waitcnt lgkmcnt(10)
    v_mfma_f32_32x32x16_bf16 a[64:79], v[160:163], v[96:99], a[64:79]
    ds_read_b64_tr_b16 v[188:189], v210 offset:3840
    ds_read_b64_tr_b16 v[190:191], v210 offset:5632
    v_fma_f32 v218, v218, v216, v217
    v_fma_f32 v219, v219, v216, v217
    v_cvt_pk_bf16_f32 v102, v218, v219
    v_mfma_f32_32x32x16_bf16 a[80:95], v[164:167], v[96:99], a[80:95]
    ds_read_b64_tr_b16 v[192:193], v211 offset:3904
    ds_read_b64_tr_b16 v[194:195], v211 offset:5696
    v_lshlrev_b32 v220, 16, v103
    v_and_b32 v221, 0xffff0000, v103
    v_fma_f32 v220, v220, v216, v217
    s_waitcnt lgkmcnt(12)
    v_mfma_f32_32x32x16_bf16 a[96:111], v[168:171], v[96:99], a[96:111]
    ds_read_b64_tr_b16 v[196:197], v210 offset:3968
    ds_read_b64_tr_b16 v[198:199], v210 offset:5760
    v_fma_f32 v221, v221, v216, v217
    v_cvt_pk_bf16_f32 v103, v220, v221
    s_waitcnt lgkmcnt(10)
    v_mfma_f32_32x32x16_bf16 a[0:15], v[172:175], v[100:103], a[0:15]
    ds_read_b64_tr_b16 v[144:145], v210 offset:7168
    ds_read_b64_tr_b16 v[146:147], v210 offset:8960
    v_lshlrev_b32 v218, 16, v104
    v_and_b32 v219, 0xffff0000, v104
    v_fma_f32 v218, v218, v216, v217
    v_mfma_f32_32x32x16_bf16 a[16:31], v[176:179], v[100:103], a[16:31]
    ds_read_b64_tr_b16 v[148:149], v211 offset:7232
    ds_read_b64_tr_b16 v[150:151], v211 offset:9024
    v_fma_f32 v219, v219, v216, v217
    v_cvt_pk_bf16_f32 v104, v218, v219
    v_lshlrev_b32 v220, 16, v105
    s_waitcnt lgkmcnt(10)
    v_mfma_f32_32x32x16_bf16 a[32:47], v[180:183], v[100:103], a[32:47]
    ds_read_b64_tr_b16 v[152:153], v210 offset:7296
    ds_read_b64_tr_b16 v[154:155], v210 offset:9088
    v_and_b32 v221, 0xffff0000, v105
    v_fma_f32 v220, v220, v216, v217
    v_fma_f32 v221, v221, v216, v217
    v_mfma_f32_32x32x16_bf16 a[48:63], v[184:187], v[100:103], a[48:63]
    ds_read_b64_tr_b16 v[156:157], v211 offset:7360
    ds_read_b64_tr_b16 v[158:159], v211 offset:9152
    v_cvt_pk_bf16_f32 v105, v220, v221
    v_lshlrev_b32 v218, 16, v106
    v_and_b32 v219, 0xffff0000, v106
    s_waitcnt lgkmcnt(10)
    v_mfma_f32_32x32x16_bf16 a[64:79], v[188:191], v[100:103], a[64:79]
    ds_read_b64_tr_b16 v[160:161], v210 offset:7424
    ds_read_b64_tr_b16 v[162:163], v210 offset:9216
    v_fma_f32 v218, v218, v216, v217
    v_fma_f32 v219, v219, v216, v217
    v_cvt_pk_bf16_f32 v106, v218, v219
    v_mfma_f32_32x32x16_bf16 a[80:95], v[192:195], v[100:103], a[80:95]
    ds_read_b64_tr_b16 v[164:165], v211 offset:7488
    ds_read_b64_tr_b16 v[166:167], v211 offset:9280
    v_lshlrev_b32 v220, 16, v107
    v_and_b32 v221, 0xffff0000, v107
    v_fma_f32 v220, v220, v216, v217
    s_waitcnt lgkmcnt(12)
    v_mfma_f32_32x32x16_bf16 a[96:111], v[196:199], v[100:103], a[96:111]
    ds_read_b64_tr_b16 v[168:169], v210 offset:7552
    ds_read_b64_tr_b16 v[170:171], v210 offset:9344
    v_fma_f32 v221, v221, v216, v217
    v_cvt_pk_bf16_f32 v107, v220, v221
    s_waitcnt lgkmcnt(10)
    v_mfma_f32_32x32x16_bf16 a[0:15], v[144:147], v[104:107], a[0:15]
    ds_read_b64_tr_b16 v[172:173], v210 offset:10752
    ds_read_b64_tr_b16 v[174:175], v210 offset:12544
    v_lshlrev_b32 v218, 16, v108
    v_and_b32 v219, 0xffff0000, v108
    v_fma_f32 v218, v218, v216, v217
    v_mfma_f32_32x32x16_bf16 a[16:31], v[148:151], v[104:107], a[16:31]
    ds_read_b64_tr_b16 v[176:177], v211 offset:10816
    ds_read_b64_tr_b16 v[178:179], v211 offset:12608
    v_fma_f32 v219, v219, v216, v217
    v_cvt_pk_bf16_f32 v108, v218, v219
    v_lshlrev_b32 v220, 16, v109
    s_waitcnt lgkmcnt(10)
    v_mfma_f32_32x32x16_bf16 a[32:47], v[152:155], v[104:107], a[32:47]
    ds_read_b64_tr_b16 v[180:181], v210 offset:10880
    ds_read_b64_tr_b16 v[182:183], v210 offset:12672
    v_and_b32 v221, 0xffff0000, v109
    v_fma_f32 v220, v220, v216, v217
    v_fma_f32 v221, v221, v216, v217
    v_mfma_f32_32x32x16_bf16 a[48:63], v[156:159], v[104:107], a[48:63]
    ds_read_b64_tr_b16 v[184:185], v211 offset:10944
    ds_read_b64_tr_b16 v[186:187], v211 offset:12736
    v_cvt_pk_bf16_f32 v109, v220, v221
    v_lshlrev_b32 v218, 16, v110
    v_and_b32 v219, 0xffff0000, v110
    s_waitcnt lgkmcnt(10)
    v_mfma_f32_32x32x16_bf16 a[64:79], v[160:163], v[104:107], a[64:79]
    ds_read_b64_tr_b16 v[188:189], v210 offset:11008
    ds_read_b64_tr_b16 v[190:191], v210 offset:12800
    v_fma_f32 v218, v218, v216, v217
    v_fma_f32 v219, v219, v216, v217
    v_cvt_pk_bf16_f32 v110, v218, v219
    v_mfma_f32_32x32x16_bf16 a[80:95], v[164:167], v[104:107], a[80:95]
    ds_read_b64_tr_b16 v[192:193], v211 offset:11072
    ds_read_b64_tr_b16 v[194:195], v211 offset:12864
    v_lshlrev_b32 v220, 16, v111
    v_and_b32 v221, 0xffff0000, v111
    v_fma_f32 v220, v220, v216, v217
    s_waitcnt lgkmcnt(12)
    v_mfma_f32_32x32x16_bf16 a[96:111], v[168:171], v[104:107], a[96:111]
    ds_read_b64_tr_b16 v[196:197], v210 offset:11136
    ds_read_b64_tr_b16 v[198:199], v210 offset:12928
    v_fma_f32 v221, v221, v216, v217
    v_cvt_pk_bf16_f32 v111, v220, v221
    s_waitcnt vmcnt(0)
    s_barrier
    s_waitcnt lgkmcnt(0)
    v_mfma_f32_32x32x16_bf16 a[0:15], v[172:175], v[108:111], a[0:15]
    ds_read_b64_tr_b16 v[16:17], v212 offset:0
    ds_read_b64_tr_b16 v[18:19], v212 offset:1792
    ds_read_b64_tr_b16 v[20:21], v212 offset:3584
    ds_read_b64_tr_b16 v[22:23], v212 offset:5376
    v_mfma_f32_32x32x16_bf16 a[16:31], v[176:179], v[108:111], a[16:31]
    ds_read_b64_tr_b16 v[24:25], v212 offset:7168
    ds_read_b64_tr_b16 v[26:27], v212 offset:8960
    ds_read_b64_tr_b16 v[28:29], v212 offset:10752
    ds_read_b64_tr_b16 v[30:31], v212 offset:12544
    v_mfma_f32_32x32x16_bf16 a[32:47], v[180:183], v[108:111], a[32:47]
    ds_read_b64_tr_b16 v[32:33], v214 offset:0
    ds_read_b64_tr_b16 v[34:35], v214 offset:1792
    ds_read_b64_tr_b16 v[36:37], v214 offset:3584
    ds_read_b64_tr_b16 v[38:39], v214 offset:5376
    v_mfma_f32_32x32x16_bf16 a[48:63], v[184:187], v[108:111], a[48:63]
    ds_read_b64_tr_b16 v[40:41], v214 offset:7168
    ds_read_b64_tr_b16 v[42:43], v214 offset:8960
    ds_read_b64_tr_b16 v[44:45], v214 offset:10752
    ds_read_b64_tr_b16 v[46:47], v214 offset:12544
    v_mfma_f32_32x32x16_bf16 a[64:79], v[188:191], v[108:111], a[64:79]
    v_mfma_f32_32x32x16_bf16 a[80:95], v[192:195], v[108:111], a[80:95]
    v_mfma_f32_32x32x16_bf16 a[96:111], v[196:199], v[108:111], a[96:111]
    v_lshlrev_b32 v222, 4, v2
    v_lshl_add_u32 v222, v3, 15, v222
    s_mul_i32 s28, s25, 917504
    s_add_u32 s28, s28, 2097152
    s_waitcnt lgkmcnt(0)
    v_mfma_f32_32x32x16_bf16 a[0:15], v[16:19], v[112:115], a[0:15]
    ds_read_b64_tr_b16 v[48:49], v213 offset:64
    ds_read_b64_tr_b16 v[50:51], v213 offset:1856
    ds_read_b64_tr_b16 v[52:53], v213 offset:3648
    ds_read_b64_tr_b16 v[54:55], v213 offset:5440
    ds_read_b64_tr_b16 v[56:57], v213 offset:7232
    ds_read_b64_tr_b16 v[58:59], v213 offset:9024
    ds_read_b64_tr_b16 v[60:61], v213 offset:10816
    ds_read_b64_tr_b16 v[62:63], v213 offset:12608
    v_mfma_f32_32x32x16_bf16 a[0:15], v[20:23], v[116:119], a[0:15]
    ds_read_b64_tr_b16 v[64:65], v215 offset:64
    ds_read_b64_tr_b16 v[66:67], v215 offset:1856
    ds_read_b64_tr_b16 v[68:69], v215 offset:3648
    ds_read_b64_tr_b16 v[70:71], v215 offset:5440
    ds_read_b64_tr_b16 v[72:73], v215 offset:7232
    ds_read_b64_tr_b16 v[74:75], v215 offset:9024
    ds_read_b64_tr_b16 v[76:77], v215 offset:10816
    ds_read_b64_tr_b16 v[78:79], v215 offset:12608
    v_mfma_f32_32x32x16_bf16 a[0:15], v[24:27], v[120:123], a[0:15]
    v_mfma_f32_32x32x16_bf16 a[0:15], v[28:31], v[124:127], a[0:15]
    v_mfma_f32_32x32x16_bf16 a[0:15], v[32:35], v[128:131], a[0:15]
    v_mfma_f32_32x32x16_bf16 a[0:15], v[36:39], v[132:135], a[0:15]
    v_mfma_f32_32x32x16_bf16 a[0:15], v[40:43], v[136:139], a[0:15]
    v_mfma_f32_32x32x16_bf16 a[0:15], v[44:47], v[140:143], a[0:15]
    s_waitcnt lgkmcnt(0)
    v_mfma_f32_32x32x16_bf16 a[16:31], v[48:51], v[112:115], a[16:31]
    ds_read_b64_tr_b16 v[16:17], v212 offset:128
    ds_read_b64_tr_b16 v[18:19], v212 offset:1920
    ds_read_b64_tr_b16 v[20:21], v212 offset:3712
    ds_read_b64_tr_b16 v[22:23], v212 offset:5504
    ds_read_b64_tr_b16 v[24:25], v212 offset:7296
    ds_read_b64_tr_b16 v[26:27], v212 offset:9088
    ds_read_b64_tr_b16 v[28:29], v212 offset:10880
    ds_read_b64_tr_b16 v[30:31], v212 offset:12672
    v_mfma_f32_32x32x16_bf16 a[16:31], v[52:55], v[116:119], a[16:31]
    ds_read_b64_tr_b16 v[32:33], v214 offset:128
    ds_read_b64_tr_b16 v[34:35], v214 offset:1920
    ds_read_b64_tr_b16 v[36:37], v214 offset:3712
    ds_read_b64_tr_b16 v[38:39], v214 offset:5504
    ds_read_b64_tr_b16 v[40:41], v214 offset:7296
    ds_read_b64_tr_b16 v[42:43], v214 offset:9088
    ds_read_b64_tr_b16 v[44:45], v214 offset:10880
    ds_read_b64_tr_b16 v[46:47], v214 offset:12672
    v_mfma_f32_32x32x16_bf16 a[16:31], v[56:59], v[120:123], a[16:31]
    v_accvgpr_read_b32 v80, a0
    v_accvgpr_read_b32 v81, a1
    v_accvgpr_read_b32 v82, a2
    v_accvgpr_read_b32 v83, a3
    v_accvgpr_read_b32 v84, a4
    v_accvgpr_read_b32 v85, a5
    v_accvgpr_read_b32 v86, a6
    v_mfma_f32_32x32x16_bf16 a[16:31], v[60:63], v[124:127], a[16:31]
    v_accvgpr_read_b32 v87, a7
    v_cvt_pk_bf16_f32 v96, v80, v81
    v_cvt_pk_bf16_f32 v97, v82, v83
    v_cvt_pk_bf16_f32 v98, v84, v85
    v_cvt_pk_bf16_f32 v99, v86, v87
    v_pk_max_i16 v96, v96, 0
    v_pk_max_i16 v97, v97, 0
    v_mfma_f32_32x32x16_bf16 a[16:31], v[64:67], v[128:131], a[16:31]
    v_pk_max_i16 v98, v98, 0
    v_pk_max_i16 v99, v99, 0
    s_add_u32 s29, s28, 0
    s_nop 0
    v_permlane32_swap_b32 v96, v98
    v_permlane32_swap_b32 v97, v99
    buffer_store_dwordx4 v[96:99], v222, s[20:23], s29 offen sc1
    v_mfma_f32_32x32x16_bf16 a[16:31], v[68:71], v[132:135], a[16:31]
    v_accvgpr_read_b32 v88, a8
    v_accvgpr_read_b32 v89, a9
    v_accvgpr_read_b32 v90, a10
    v_accvgpr_read_b32 v91, a11
    v_accvgpr_read_b32 v92, a12
    v_accvgpr_read_b32 v93, a13
    v_accvgpr_read_b32 v94, a14
    v_mfma_f32_32x32x16_bf16 a[16:31], v[72:75], v[136:139], a[16:31]
    v_accvgpr_read_b32 v95, a15
    v_cvt_pk_bf16_f32 v100, v88, v89
    v_cvt_pk_bf16_f32 v101, v90, v91
    v_cvt_pk_bf16_f32 v102, v92, v93
    v_cvt_pk_bf16_f32 v103, v94, v95
    v_pk_max_i16 v100, v100, 0
    v_pk_max_i16 v101, v101, 0
    v_mfma_f32_32x32x16_bf16 a[16:31], v[76:79], v[140:143], a[16:31]
    v_pk_max_i16 v102, v102, 0
    v_pk_max_i16 v103, v103, 0
    s_add_u32 s29, s28, 65536
    s_nop 0
    v_permlane32_swap_b32 v100, v102
    v_permlane32_swap_b32 v101, v103
    buffer_store_dwordx4 v[100:103], v222, s[20:23], s29 offen sc1
    s_waitcnt lgkmcnt(0)
    v_mfma_f32_32x32x16_bf16 a[32:47], v[16:19], v[112:115], a[32:47]
    ds_read_b64_tr_b16 v[48:49], v213 offset:192
    ds_read_b64_tr_b16 v[50:51], v213 offset:1984
    ds_read_b64_tr_b16 v[52:53], v213 offset:3776
    ds_read_b64_tr_b16 v[54:55], v213 offset:5568
    ds_read_b64_tr_b16 v[56:57], v213 offset:7360
    ds_read_b64_tr_b16 v[58:59], v213 offset:9152
    ds_read_b64_tr_b16 v[60:61], v213 offset:10944
    ds_read_b64_tr_b16 v[62:63], v213 offset:12736
    v_mfma_f32_32x32x16_bf16 a[32:47], v[20:23], v[116:119], a[32:47]
    ds_read_b64_tr_b16 v[64:65], v215 offset:192
    ds_read_b64_tr_b16 v[66:67], v215 offset:1984
    ds_read_b64_tr_b16 v[68:69], v215 offset:3776
    ds_read_b64_tr_b16 v[70:71], v215 offset:5568
    ds_read_b64_tr_b16 v[72:73], v215 offset:7360
    ds_read_b64_tr_b16 v[74:75], v215 offset:9152
    ds_read_b64_tr_b16 v[76:77], v215 offset:10944
    ds_read_b64_tr_b16 v[78:79], v215 offset:12736
    v_mfma_f32_32x32x16_bf16 a[32:47], v[24:27], v[120:123], a[32:47]
    v_accvgpr_read_b32 v80, a16
    v_accvgpr_read_b32 v81, a17
    v_accvgpr_read_b32 v82, a18
    v_accvgpr_read_b32 v83, a19
    v_accvgpr_read_b32 v84, a20
    v_accvgpr_read_b32 v85, a21
    v_accvgpr_read_b32 v86, a22
    v_mfma_f32_32x32x16_bf16 a[32:47], v[28:31], v[124:127], a[32:47]
    v_accvgpr_read_b32 v87, a23
    v_cvt_pk_bf16_f32 v104, v80, v81
    v_cvt_pk_bf16_f32 v105, v82, v83
    v_cvt_pk_bf16_f32 v106, v84, v85
    v_cvt_pk_bf16_f32 v107, v86, v87
    v_pk_max_i16 v104, v104, 0
    v_pk_max_i16 v105, v105, 0
    v_mfma_f32_32x32x16_bf16 a[32:47], v[32:35], v[128:131], a[32:47]
    v_pk_max_i16 v106, v106, 0
    v_pk_max_i16 v107, v107, 0
    s_add_u32 s29, s28, 131072
    s_nop 0
    v_permlane32_swap_b32 v104, v106
    v_permlane32_swap_b32 v105, v107
    buffer_store_dwordx4 v[104:107], v222, s[20:23], s29 offen sc1
    v_mfma_f32_32x32x16_bf16 a[32:47], v[36:39], v[132:135], a[32:47]
    v_accvgpr_read_b32 v88, a24
    v_accvgpr_read_b32 v89, a25
    v_accvgpr_read_b32 v90, a26
    v_accvgpr_read_b32 v91, a27
    v_accvgpr_read_b32 v92, a28
    v_accvgpr_read_b32 v93, a29
    v_accvgpr_read_b32 v94, a30
    v_mfma_f32_32x32x16_bf16 a[32:47], v[40:43], v[136:139], a[32:47]
    v_accvgpr_read_b32 v95, a31
    v_cvt_pk_bf16_f32 v108, v88, v89
    v_cvt_pk_bf16_f32 v109, v90, v91
    v_cvt_pk_bf16_f32 v110, v92, v93
    v_cvt_pk_bf16_f32 v111, v94, v95
    v_pk_max_i16 v108, v108, 0
    v_pk_max_i16 v109, v109, 0
    v_mfma_f32_32x32x16_bf16 a[32:47], v[44:47], v[140:143], a[32:47]
    v_pk_max_i16 v110, v110, 0
    v_pk_max_i16 v111, v111, 0
    s_add_u32 s29, s28, 196608
    s_nop 0
    v_permlane32_swap_b32 v108, v110
    v_permlane32_swap_b32 v109, v111
    buffer_store_dwordx4 v[108:111], v222, s[20:23], s29 offen sc1
    s_waitcnt lgkmcnt(0)
    v_mfma_f32_32x32x16_bf16 a[48:63], v[48:51], v[112:115], a[48:63]
    ds_read_b64_tr_b16 v[16:17], v212 offset:256
    ds_read_b64_tr_b16 v[18:19], v212 offset:2048
    ds_read_b64_tr_b16 v[20:21], v212 offset:3840
    ds_read_b64_tr_b16 v[22:23], v212 offset:5632
    ds_read_b64_tr_b16 v[24:25], v212 offset:7424
    ds_read_b64_tr_b16 v[26:27], v212 offset:9216
    ds_read_b64_tr_b16 v[28:29], v212 offset:11008
    ds_read_b64_tr_b16 v[30:31], v212 offset:12800
    v_mfma_f32_32x32x16_bf16 a[48:63], v[52:55], v[116:119], a[48:63]
    ds_read_b64_tr_b16 v[32:33], v214 offset:256
    ds_read_b64_tr_b16 v[34:35], v214 offset:2048
    ds_read_b64_tr_b16 v[36:37], v214 offset:3840
    ds_read_b64_tr_b16 v[38:39], v214 offset:5632
    ds_read_b64_tr_b16 v[40:41], v214 offset:7424
    ds_read_b64_tr_b16 v[42:43], v214 offset:9216
    ds_read_b64_tr_b16 v[44:45], v214 offset:11008
    ds_read_b64_tr_b16 v[46:47], v214 offset:12800
    v_mfma_f32_32x32x16_bf16 a[48:63], v[56:59], v[120:123], a[48:63]
    v_accvgpr_read_b32 v80, a32
    v_accvgpr_read_b32 v81, a33
    v_accvgpr_read_b32 v82, a34
    v_accvgpr_read_b32 v83, a35
    v_accvgpr_read_b32 v84, a36
    v_accvgpr_read_b32 v85, a37
    v_accvgpr_read_b32 v86, a38
    v_mfma_f32_32x32x16_bf16 a[48:63], v[60:63], v[124:127], a[48:63]
    v_accvgpr_read_b32 v87, a39
    v_cvt_pk_bf16_f32 v96, v80, v81
    v_cvt_pk_bf16_f32 v97, v82, v83
    v_cvt_pk_bf16_f32 v98, v84, v85
    v_cvt_pk_bf16_f32 v99, v86, v87
    v_pk_max_i16 v96, v96, 0
    v_pk_max_i16 v97, v97, 0
    v_mfma_f32_32x32x16_bf16 a[48:63], v[64:67], v[128:131], a[48:63]
    v_pk_max_i16 v98, v98, 0
    v_pk_max_i16 v99, v99, 0
    s_add_u32 s29, s28, 262144
    s_nop 0
    v_permlane32_swap_b32 v96, v98
    v_permlane32_swap_b32 v97, v99
    buffer_store_dwordx4 v[96:99], v222, s[20:23], s29 offen sc1
    v_mfma_f32_32x32x16_bf16 a[48:63], v[68:71], v[132:135], a[48:63]
    v_accvgpr_read_b32 v88, a40
    v_accvgpr_read_b32 v89, a41
    v_accvgpr_read_b32 v90, a42
    v_accvgpr_read_b32 v91, a43
    v_accvgpr_read_b32 v92, a44
    v_accvgpr_read_b32 v93, a45
    v_accvgpr_read_b32 v94, a46
    v_mfma_f32_32x32x16_bf16 a[48:63], v[72:75], v[136:139], a[48:63]
    v_accvgpr_read_b32 v95, a47
    v_cvt_pk_bf16_f32 v100, v88, v89
    v_cvt_pk_bf16_f32 v101, v90, v91
    v_cvt_pk_bf16_f32 v102, v92, v93
    v_cvt_pk_bf16_f32 v103, v94, v95
    v_pk_max_i16 v100, v100, 0
    v_pk_max_i16 v101, v101, 0
    v_mfma_f32_32x32x16_bf16 a[48:63], v[76:79], v[140:143], a[48:63]
    v_pk_max_i16 v102, v102, 0
    v_pk_max_i16 v103, v103, 0
    s_add_u32 s29, s28, 327680
    s_nop 0
    v_permlane32_swap_b32 v100, v102
    v_permlane32_swap_b32 v101, v103
    buffer_store_dwordx4 v[100:103], v222, s[20:23], s29 offen sc1
    s_waitcnt lgkmcnt(0)
    v_mfma_f32_32x32x16_bf16 a[64:79], v[16:19], v[112:115], a[64:79]
    ds_read_b64_tr_b16 v[48:49], v213 offset:320
    ds_read_b64_tr_b16 v[50:51], v213 offset:2112
    ds_read_b64_tr_b16 v[52:53], v213 offset:3904
    ds_read_b64_tr_b16 v[54:55], v213 offset:5696
    ds_read_b64_tr_b16 v[56:57], v213 offset:7488
    ds_read_b64_tr_b16 v[58:59], v213 offset:9280
    ds_read_b64_tr_b16 v[60:61], v213 offset:11072
    ds_read_b64_tr_b16 v[62:63], v213 offset:12864
    v_mfma_f32_32x32x16_bf16 a[64:79], v[20:23], v[116:119], a[64:79]
    ds_read_b64_tr_b16 v[64:65], v215 offset:320
    ds_read_b64_tr_b16 v[66:67], v215 offset:2112
    ds_read_b64_tr_b16 v[68:69], v215 offset:3904
    ds_read_b64_tr_b16 v[70:71], v215 offset:5696
    ds_read_b64_tr_b16 v[72:73], v215 offset:7488
    ds_read_b64_tr_b16 v[74:75], v215 offset:9280
    ds_read_b64_tr_b16 v[76:77], v215 offset:11072
    ds_read_b64_tr_b16 v[78:79], v215 offset:12864
    v_mfma_f32_32x32x16_bf16 a[64:79], v[24:27], v[120:123], a[64:79]
    v_accvgpr_read_b32 v80, a48
    v_accvgpr_read_b32 v81, a49
    v_accvgpr_read_b32 v82, a50
    v_accvgpr_read_b32 v83, a51
    v_accvgpr_read_b32 v84, a52
    v_accvgpr_read_b32 v85, a53
    v_accvgpr_read_b32 v86, a54
    v_mfma_f32_32x32x16_bf16 a[64:79], v[28:31], v[124:127], a[64:79]
    v_accvgpr_read_b32 v87, a55
    v_cvt_pk_bf16_f32 v104, v80, v81
    v_cvt_pk_bf16_f32 v105, v82, v83
    v_cvt_pk_bf16_f32 v106, v84, v85
    v_cvt_pk_bf16_f32 v107, v86, v87
    v_pk_max_i16 v104, v104, 0
    v_pk_max_i16 v105, v105, 0
    v_mfma_f32_32x32x16_bf16 a[64:79], v[32:35], v[128:131], a[64:79]
    v_pk_max_i16 v106, v106, 0
    v_pk_max_i16 v107, v107, 0
    s_add_u32 s29, s28, 393216
    s_nop 0
    v_permlane32_swap_b32 v104, v106
    v_permlane32_swap_b32 v105, v107
    buffer_store_dwordx4 v[104:107], v222, s[20:23], s29 offen sc1
    v_mfma_f32_32x32x16_bf16 a[64:79], v[36:39], v[132:135], a[64:79]
    v_accvgpr_read_b32 v88, a56
    v_accvgpr_read_b32 v89, a57
    v_accvgpr_read_b32 v90, a58
    v_accvgpr_read_b32 v91, a59
    v_accvgpr_read_b32 v92, a60
    v_accvgpr_read_b32 v93, a61
    v_accvgpr_read_b32 v94, a62
    v_mfma_f32_32x32x16_bf16 a[64:79], v[40:43], v[136:139], a[64:79]
    v_accvgpr_read_b32 v95, a63
    v_cvt_pk_bf16_f32 v108, v88, v89
    v_cvt_pk_bf16_f32 v109, v90, v91
    v_cvt_pk_bf16_f32 v110, v92, v93
    v_cvt_pk_bf16_f32 v111, v94, v95
    v_pk_max_i16 v108, v108, 0
    v_pk_max_i16 v109, v109, 0
    v_mfma_f32_32x32x16_bf16 a[64:79], v[44:47], v[140:143], a[64:79]
    v_pk_max_i16 v110, v110, 0
    v_pk_max_i16 v111, v111, 0
    s_add_u32 s29, s28, 458752
    s_nop 0
    v_permlane32_swap_b32 v108, v110
    v_permlane32_swap_b32 v109, v111
    buffer_store_dwordx4 v[108:111], v222, s[20:23], s29 offen sc1
    s_waitcnt lgkmcnt(0)
    v_mfma_f32_32x32x16_bf16 a[80:95], v[48:51], v[112:115], a[80:95]
    ds_read_b64_tr_b16 v[16:17], v212 offset:384
    ds_read_b64_tr_b16 v[18:19], v212 offset:2176
    ds_read_b64_tr_b16 v[20:21], v212 offset:3968
    ds_read_b64_tr_b16 v[22:23], v212 offset:5760
    ds_read_b64_tr_b16 v[24:25], v212 offset:7552
    ds_read_b64_tr_b16 v[26:27], v212 offset:9344
    ds_read_b64_tr_b16 v[28:29], v212 offset:11136
    ds_read_b64_tr_b16 v[30:31], v212 offset:12928
    v_mfma_f32_32x32x16_bf16 a[80:95], v[52:55], v[116:119], a[80:95]
    ds_read_b64_tr_b16 v[32:33], v214 offset:384
    ds_read_b64_tr_b16 v[34:35], v214 offset:2176
    ds_read_b64_tr_b16 v[36:37], v214 offset:3968
    ds_read_b64_tr_b16 v[38:39], v214 offset:5760
    ds_read_b64_tr_b16 v[40:41], v214 offset:7552
    ds_read_b64_tr_b16 v[42:43], v214 offset:9344
    ds_read_b64_tr_b16 v[44:45], v214 offset:11136
    ds_read_b64_tr_b16 v[46:47], v214 offset:12928
    v_mfma_f32_32x32x16_bf16 a[80:95], v[56:59], v[120:123], a[80:95]
    v_accvgpr_read_b32 v80, a64
    v_accvgpr_read_b32 v81, a65
    v_accvgpr_read_b32 v82, a66
    v_accvgpr_read_b32 v83, a67
    v_accvgpr_read_b32 v84, a68
    v_accvgpr_read_b32 v85, a69
    v_accvgpr_read_b32 v86, a70
    v_mfma_f32_32x32x16_bf16 a[80:95], v[60:63], v[124:127], a[80:95]
    v_accvgpr_read_b32 v87, a71
    v_cvt_pk_bf16_f32 v96, v80, v81
    v_cvt_pk_bf16_f32 v97, v82, v83
    v_cvt_pk_bf16_f32 v98, v84, v85
    v_cvt_pk_bf16_f32 v99, v86, v87
    v_pk_max_i16 v96, v96, 0
    v_pk_max_i16 v97, v97, 0
    v_mfma_f32_32x32x16_bf16 a[80:95], v[64:67], v[128:131], a[80:95]
    v_pk_max_i16 v98, v98, 0
    v_pk_max_i16 v99, v99, 0
    s_add_u32 s29, s28, 524288
    s_nop 0
    v_permlane32_swap_b32 v96, v98
    v_permlane32_swap_b32 v97, v99
    buffer_store_dwordx4 v[96:99], v222, s[20:23], s29 offen sc1
    v_mfma_f32_32x32x16_bf16 a[80:95], v[68:71], v[132:135], a[80:95]
    v_accvgpr_read_b32 v88, a72
    v_accvgpr_read_b32 v89, a73
    v_accvgpr_read_b32 v90, a74
    v_accvgpr_read_b32 v91, a75
    v_accvgpr_read_b32 v92, a76
    v_accvgpr_read_b32 v93, a77
    v_accvgpr_read_b32 v94, a78
    v_mfma_f32_32x32x16_bf16 a[80:95], v[72:75], v[136:139], a[80:95]
    v_accvgpr_read_b32 v95, a79
    v_cvt_pk_bf16_f32 v100, v88, v89
    v_cvt_pk_bf16_f32 v101, v90, v91
    v_cvt_pk_bf16_f32 v102, v92, v93
    v_cvt_pk_bf16_f32 v103, v94, v95
    v_pk_max_i16 v100, v100, 0
    v_pk_max_i16 v101, v101, 0
    v_mfma_f32_32x32x16_bf16 a[80:95], v[76:79], v[140:143], a[80:95]
    v_pk_max_i16 v102, v102, 0
    v_pk_max_i16 v103, v103, 0
    s_add_u32 s29, s28, 589824
    s_nop 0
    v_permlane32_swap_b32 v100, v102
    v_permlane32_swap_b32 v101, v103
    buffer_store_dwordx4 v[100:103], v222, s[20:23], s29 offen sc1
    s_waitcnt lgkmcnt(0)
    v_mfma_f32_32x32x16_bf16 a[96:111], v[16:19], v[112:115], a[96:111]
    v_mfma_f32_32x32x16_bf16 a[96:111], v[20:23], v[116:119], a[96:111]
    v_mfma_f32_32x32x16_bf16 a[96:111], v[24:27], v[120:123], a[96:111]
    v_accvgpr_read_b32 v80, a80
    v_accvgpr_read_b32 v81, a81
    v_accvgpr_read_b32 v82, a82
    v_accvgpr_read_b32 v83, a83
    v_accvgpr_read_b32 v84, a84
    v_accvgpr_read_b32 v85, a85
    v_accvgpr_read_b32 v86, a86
    v_mfma_f32_32x32x16_bf16 a[96:111], v[28:31], v[124:127], a[96:111]
    v_accvgpr_read_b32 v87, a87
    v_cvt_pk_bf16_f32 v104, v80, v81
    v_cvt_pk_bf16_f32 v105, v82, v83
    v_cvt_pk_bf16_f32 v106, v84, v85
    v_cvt_pk_bf16_f32 v107, v86, v87
    v_pk_max_i16 v104, v104, 0
    v_pk_max_i16 v105, v105, 0
    v_mfma_f32_32x32x16_bf16 a[96:111], v[32:35], v[128:131], a[96:111]
    v_pk_max_i16 v106, v106, 0
    v_pk_max_i16 v107, v107, 0
    s_add_u32 s29, s28, 655360
    s_nop 0
    v_permlane32_swap_b32 v104, v106
    v_permlane32_swap_b32 v105, v107
    buffer_store_dwordx4 v[104:107], v222, s[20:23], s29 offen sc1
    v_mfma_f32_32x32x16_bf16 a[96:111], v[36:39], v[132:135], a[96:111]
    v_accvgpr_read_b32 v88, a88
    v_accvgpr_read_b32 v89, a89
    v_accvgpr_read_b32 v90, a90
    v_accvgpr_read_b32 v91, a91
    v_accvgpr_read_b32 v92, a92
    v_accvgpr_read_b32 v93, a93
    v_accvgpr_read_b32 v94, a94
    v_mfma_f32_32x32x16_bf16 a[96:111], v[40:43], v[136:139], a[96:111]
    v_accvgpr_read_b32 v95, a95
    v_cvt_pk_bf16_f32 v108, v88, v89
    v_cvt_pk_bf16_f32 v109, v90, v91
    v_cvt_pk_bf16_f32 v110, v92, v93
    v_cvt_pk_bf16_f32 v111, v94, v95
    v_pk_max_i16 v108, v108, 0
    v_pk_max_i16 v109, v109, 0
    v_mfma_f32_32x32x16_bf16 a[96:111], v[44:47], v[140:143], a[96:111]
    v_pk_max_i16 v110, v110, 0
    v_pk_max_i16 v111, v111, 0
    s_add_u32 s29, s28, 720896
    s_nop 0
    v_permlane32_swap_b32 v108, v110
    v_permlane32_swap_b32 v109, v111
    buffer_store_dwordx4 v[108:111], v222, s[20:23], s29 offen sc1
    s_nop 15
    s_nop 3
    v_accvgpr_read_b32 v80, a96
    v_accvgpr_read_b32 v81, a97
    v_accvgpr_read_b32 v82, a98
    v_accvgpr_read_b32 v83, a99
    v_accvgpr_read_b32 v84, a100
    v_accvgpr_read_b32 v85, a101
    v_accvgpr_read_b32 v86, a102
    v_accvgpr_read_b32 v87, a103
    v_cvt_pk_bf16_f32 v96, v80, v81
    v_cvt_pk_bf16_f32 v97, v82, v83
    v_cvt_pk_bf16_f32 v98, v84, v85
    v_cvt_pk_bf16_f32 v99, v86, v87
    v_pk_max_i16 v96, v96, 0
    v_pk_max_i16 v97, v97, 0
    v_pk_max_i16 v98, v98, 0
    v_pk_max_i16 v99, v99, 0
    s_add_u32 s29, s28, 786432
    s_nop 0
    v_permlane32_swap_b32 v96, v98
    v_permlane32_swap_b32 v97, v99
    buffer_store_dwordx4 v[96:99], v222, s[20:23], s29 offen sc1
    v_accvgpr_read_b32 v88, a104
    v_accvgpr_read_b32 v89, a105
    v_accvgpr_read_b32 v90, a106
    v_accvgpr_read_b32 v91, a107
    v_accvgpr_read_b32 v92, a108
    v_accvgpr_read_b32 v93, a109
    v_accvgpr_read_b32 v94, a110
    v_accvgpr_read_b32 v95, a111
    v_cvt_pk_bf16_f32 v100, v88, v89
    v_cvt_pk_bf16_f32 v101, v90, v91
    v_cvt_pk_bf16_f32 v102, v92, v93
    v_cvt_pk_bf16_f32 v103, v94, v95
    v_pk_max_i16 v100, v100, 0
    v_pk_max_i16 v101, v101, 0
    v_pk_max_i16 v102, v102, 0
    v_pk_max_i16 v103, v103, 0
    s_add_u32 s29, s28, 851968
    s_nop 0
    v_permlane32_swap_b32 v100, v102
    v_permlane32_swap_b32 v101, v103
    buffer_store_dwordx4 v[100:103], v222, s[20:23], s29 offen sc1
    s_endpgm
LA_exit:
    s_endpgm
.globl attn_kernel
.p2align 8
.type attn_kernel,@function
attn_kernel:
    s_cmp_ge_u32 s2, 256
    s_cbranch_scc1 LB_exit
    s_load_dwordx2 s[10:11], s[0:1], 64
    v_and_b32 v1, 63, v0
    v_lshrrev_b32 v2, 6, v0
    s_nop 0
    v_readfirstlane_b32 s26, v2
    s_and_b32 s24, s2, 7
    s_lshl_b32 s24, s24, 2
    s_bfe_u32 s25, s2, 0x20003
    s_add_u32 s24, s24, s25
    s_lshr_b32 s25, s2, 5
    v_and_b32 v2, 31, v1
    v_lshrrev_b32 v3, 5, v1
    s_lshl_b32 s27, s24, 16
    s_lshl_b32 s28, s25, 8
    s_lshl_b32 s29, s26, 5
    s_add_u32 s28, s28, s29
    v_add_u32 v125, s28, v2
    v_lshlrev_b32 v118, 4, v125
    v_lshl_add_u32 v118, v3, 15, v118
    v_lshlrev_b32 v124, 4, v1
    s_lshr_b32 s28, s26, 2
    s_and_b32 s29, s26, 3
    s_lshl_b32 s29, s29, 10
    s_lshl_b32 s32, s28, 15
    s_add_u32 s32, s32, s29
    s_add_u32 s30, s27, s32
    s_add_u32 s31, s30, 4194304
    s_add_u32 s30, s30, 2097152
    s_lshl_b32 s28, s28, 6
    s_add_u32 s35, s32, s28
    s_add_u32 s35, s35, 65536
    s_waitcnt lgkmcnt(0)
    s_mov_b32 s12, s10
    s_mov_b32 s13, s11
    s_mov_b32 s14, 6291456
    s_mov_b32 s15, 0x00020000
    s_cmp_ge_u32 s26, 8
    s_cbranch_scc1 LB_gemm
    buffer_load_dwordx4 v[4:7], v118, s[12:15], s27 offen
    s_add_u32 m0, s32, 0
    s_add_u32 s28, s30, 0
    buffer_load_dwordx4 v124, s[12:15], s28 offen lds
    s_add_u32 m0, s35, 0
    s_add_u32 s28, s31, 0
    buffer_load_dwordx4 v124, s[12:15], s28 offen lds
    s_add_u32 m0, s32, 4096
    s_add_u32 s28, s30, 4096
    buffer_load_dwordx4 v124, s[12:15], s28 offen lds
    s_add_u32 m0, s35, 4096
    s_add_u32 s28, s31, 4096
    buffer_load_dwordx4 v124, s[12:15], s28 offen lds
    s_add_u32 s20, s10, 8388608
    s_addc_u32 s21, s11, 0
    s_mov_b32 s22, 9437184
    s_mov_b32 s23, 0x00020000
    v_and_b32 v118, 15, v0
    v_cmp_eq_u32 vcc, 8, v118
    v_mov_b32 v120, 0
    v_mov_b32 v121, 0
    v_mov_b32 v119, 0x3f80
    v_cndmask_b32 v120, v120, v119, vcc
    v_lshlrev_b32 v118, 3, v0
    v_add_u32 v118, 131328, v118
    ds_write_b64 v118, v[120:121] offset:0
    ds_write_b64 v118, v[120:121] offset:4096
    v_lshlrev_b32 v113, 4, v2
    v_lshl_add_u32 v113, v3, 15, v113
    v_bfe_u32 v118, v1, 2, 2
    v_lshl_add_u32 v118, v3, 2, v118
    v_lshlrev_b32 v118, 4, v118
    v_and_b32 v119, 1, v1
    v_lshl_add_u32 v118, v119, 3, v118
    v_bfe_u32 v119, v1, 1, 1
    v_mul_u32_u24 v120, 32832, v119
    v_add_u32 v118, v118, v120
    v_add_u32 v118, 65536, v118
    v_lshlrev_b32 v119, 3, v119
    v_add_u32 v119, 131520, v119
    v_and_b32 v120, 16, v1
    v_cmp_eq_u32 vcc, 0, v120
    v_cndmask_b32 v114, v119, v118, vcc
    v_mov_b32 v119, 0
    v_mov_b32 v120, 4096
    v_cndmask_b32 v115, v119, v120, vcc
    v_mov_b32 v80, 0
    v_mov_b32 v81, 0
    v_mov_b32 v82, 0
    v_mov_b32 v83, 0
    v_mov_b32 v84, 0
    v_mov_b32 v85, 0
    v_mov_b32 v86, 0
    v_mov_b32 v87, 0
    v_mov_b32 v88, 0
    v_mov_b32 v89, 0
    v_mov_b32 v90, 0
    v_mov_b32 v91, 0
    v_mov_b32 v92, 0
    v_mov_b32 v93, 0
    v_mov_b32 v94, 0
    v_mov_b32 v95, 0
    s_mov_b32 s33, 0
    s_lshr_b32 s37, s26, 2
    s_mov_b32 s34, 0x71800000
    s_waitcnt vmcnt(2) lgkmcnt(0)
    s_barrier
    ds_read_b128 v[8:11], v113
    ds_read_b128 v[12:15], v113 offset:512
    s_waitcnt lgkmcnt(0)
    v_mfma_f32_32x32x16_bf16 v[32:47], v[8:11], v[4:7], 0
    v_mfma_f32_32x32x16_bf16 v[48:63], v[12:15], v[4:7], 0
    s_nop 15
    s_nop 7
    v_max_f32 v32, v32, v48
    v_max_f32 v33, v33, v49
    v_max_f32 v34, v34, v50
    v_max_f32 v35, v35, v51
    v_max_f32 v36, v36, v52
    v_max_f32 v37, v37, v53
    v_max_f32 v38, v38, v54
    v_max_f32 v39, v39, v55
    v_max_f32 v40, v40, v56
    v_max_f32 v41, v41, v57
    v_max_f32 v42, v42, v58
    v_max_f32 v43, v43, v59
    v_max_f32 v44, v44, v60
    v_max_f32 v45, v45, v61
    v_max_f32 v46, v46, v62
    v_max_f32 v47, v47, v63
    v_max3_f32 v118, v32, v33, v34
    v_max3_f32 v118, v118, v35, v36
    v_max3_f32 v118, v118, v37, v38
    v_max3_f32 v118, v118, v39, v40
    v_max3_f32 v118, v118, v41, v42
    v_max3_f32 v118, v118, v43, v44
    v_max3_f32 v118, v118, v45, v46
    v_max_f32 v118, v118, v47
    v_mov_b32 v119, v118
    s_nop 1
    v_permlane32_swap_b32 v118, v119
    s_nop 1
    v_max_f32 v118, v118, v119
    v_sub_f32 v64, 0xc2a00000, v118
    v_sub_f32 v65, 0xc2a00000, v118
    v_sub_f32 v66, 0xc2a00000, v118
    v_sub_f32 v67, 0xc2a00000, v118
    v_sub_f32 v68, 0xc2a00000, v118
    v_sub_f32 v69, 0xc2a00000, v118
    v_sub_f32 v70, 0xc2a00000, v118
    v_sub_f32 v71, 0xc2a00000, v118
    v_sub_f32 v72, 0xc2a00000, v118
    v_sub_f32 v73, 0xc2a00000, v118
    v_sub_f32 v74, 0xc2a00000, v118
    v_sub_f32 v75, 0xc2a00000, v118
    v_sub_f32 v76, 0xc2a00000, v118
    v_sub_f32 v77, 0xc2a00000, v118
    v_sub_f32 v78, 0xc2a00000, v118
    v_sub_f32 v79, 0xc2a00000, v118
    v_mov_b32 v116, v113
    v_mov_b32 v117, v114
    ds_read_b64_tr_b16 v[16:17], v114 offset:0
    ds_read_b64_tr_b16 v[18:19], v114 offset:128
    ds_read_b64_tr_b16 v[20:21], v114 offset:256
    ds_read_b64_tr_b16 v[22:23], v114 offset:384
    v_mfma_f32_32x32x16_bf16 v[32:47], v[8:11], v[4:7], v[64:79]
    s_nop 15
    v_exp_f32 v32, v32
    v_exp_f32 v33, v33
    s_add_u32 m0, s32, 8192
    s_add_u32 s28, s30, 8192
    buffer_load_dwordx4 v124, s[12:15], s28 offen lds
    v_exp_f32 v34, v34
    v_exp_f32 v35, v35
    v_exp_f32 v36, v36
    v_exp_f32 v37, v37
    v_exp_f32 v38, v38
    v_cvt_pk_bf16_f32 v96, v32, v33
    v_exp_f32 v39, v39
    ds_read_b64_tr_b16 v[24:25], v114 offset:512
    ds_read_b64_tr_b16 v[26:27], v114 offset:640
    v_exp_f32 v40, v40
    v_cvt_pk_bf16_f32 v97, v34, v35
    ds_read_b64_tr_b16 v[28:29], v114 offset:768
    ds_read_b64_tr_b16 v[30:31], v114 offset:896
    v_exp_f32 v41, v41
    v_exp_f32 v42, v42
    v_cvt_pk_bf16_f32 v98, v36, v37
    s_waitcnt lgkmcnt(4)
    v_mfma_f32_32x32x16_bf16 v[48:63], v[12:15], v[4:7], v[64:79]
    v_exp_f32 v43, v43
    ds_read_b128 v[8:11], v113 offset:1024
    v_exp_f32 v44, v44
    v_cvt_pk_bf16_f32 v99, v38, v39
    s_add_u32 m0, s35, 8192
    s_add_u32 s28, s31, 8192
    buffer_load_dwordx4 v124, s[12:15], s28 offen lds
    v_exp_f32 v45, v45
    v_exp_f32 v46, v46
    v_cvt_pk_bf16_f32 v100, v40, v41
    v_mfma_f32_32x32x16_bf16 v[80:95], v[16:19], v[96:99], v[80:95]
    v_exp_f32 v47, v47
    v_exp_f32 v48, v48
    v_cvt_pk_bf16_f32 v101, v42, v43
    v_exp_f32 v49, v49
    s_add_u32 m0, s32, 12288
    s_add_u32 s28, s30, 12288
    buffer_load_dwordx4 v124, s[12:15], s28 offen lds
    v_exp_f32 v50, v50
    v_cvt_pk_bf16_f32 v102, v44, v45
    v_exp_f32 v51, v51
    v_exp_f32 v52, v52
    v_cvt_pk_bf16_f32 v103, v46, v47
    v_exp_f32 v53, v53
    v_exp_f32 v54, v54
    v_cvt_pk_bf16_f32 v96, v48, v49
    v_mfma_f32_32x32x16_bf16 v[80:95], v[20:23], v[100:103], v[80:95]
    v_exp_f32 v55, v55
    ds_read_b64_tr_b16 v[16:17], v114 offset:1024
    ds_read_b64_tr_b16 v[18:19], v114 offset:1152
    v_exp_f32 v56, v56
    v_cvt_pk_bf16_f32 v97, v50, v51
    ds_read_b64_tr_b16 v[20:21], v114 offset:1280
    ds_read_b64_tr_b16 v[22:23], v114 offset:1408
    v_exp_f32 v57, v57
    v_exp_f32 v58, v58
    v_cvt_pk_bf16_f32 v98, v52, v53
    s_waitcnt lgkmcnt(4)
    v_mfma_f32_32x32x16_bf16 v[32:47], v[8:11], v[4:7], v[64:79]
    v_exp_f32 v59, v59
    ds_read_b128 v[12:15], v113 offset:1536
    v_exp_f32 v60, v60
    v_cvt_pk_bf16_f32 v99, v54, v55
    s_add_u32 m0, s35, 12288
    s_add_u32 s28, s31, 12288
    buffer_load_dwordx4 v124, s[12:15], s28 offen lds
    v_exp_f32 v61, v61
    v_exp_f32 v62, v62
    v_cvt_pk_bf16_f32 v100, v56, v57
    v_mfma_f32_32x32x16_bf16 v[80:95], v[24:27], v[96:99], v[80:95]
    v_exp_f32 v63, v63
    v_exp_f32 v32, v32
    v_cvt_pk_bf16_f32 v101, v58, v59
    v_exp_f32 v33, v33
    s_add_u32 m0, s32, 16384
    s_add_u32 s28, s30, 16384
    buffer_load_dwordx4 v124, s[12:15], s28 offen lds
    v_exp_f32 v34, v34
    v_cvt_pk_bf16_f32 v102, v60, v61
    v_exp_f32 v35, v35
    v_exp_f32 v36, v36
    v_cvt_pk_bf16_f32 v103, v62, v63
    v_exp_f32 v37, v37
    v_exp_f32 v38, v38
    v_cvt_pk_bf16_f32 v96, v32, v33
    v_mfma_f32_32x32x16_bf16 v[80:95], v[28:31], v[100:103], v[80:95]
    v_exp_f32 v39, v39
    ds_read_b64_tr_b16 v[24:25], v114 offset:1536
    ds_read_b64_tr_b16 v[26:27], v114 offset:1664
    v_exp_f32 v40, v40
    v_cvt_pk_bf16_f32 v97, v34, v35
    ds_read_b64_tr_b16 v[28:29], v114 offset:1792
    ds_read_b64_tr_b16 v[30:31], v114 offset:1920
    v_exp_f32 v41, v41
    v_exp_f32 v42, v42
    v_cvt_pk_bf16_f32 v98, v36, v37
    s_waitcnt lgkmcnt(4)
    v_mfma_f32_32x32x16_bf16 v[48:63], v[12:15], v[4:7], v[64:79]
    v_exp_f32 v43, v43
    ds_read_b128 v[8:11], v113 offset:2048
    v_exp_f32 v44, v44
    v_cvt_pk_bf16_f32 v99, v38, v39
    s_add_u32 m0, s35, 16384
    s_add_u32 s28, s31, 16384
    buffer_load_dwordx4 v124, s[12:15], s28 offen lds
    v_exp_f32 v45, v45
    v_exp_f32 v46, v46
    v_cvt_pk_bf16_f32 v100, v40, v41
    v_mfma_f32_32x32x16_bf16 v[80:95], v[16:19], v[96:99], v[80:95]
    v_exp_f32 v47, v47
    v_exp_f32 v48, v48
    v_cvt_pk_bf16_f32 v101, v42, v43
    v_exp_f32 v49, v49
    s_add_u32 m0, s32, 20480
    s_add_u32 s28, s30, 20480
    buffer_load_dwordx4 v124, s[12:15], s28 offen lds
    v_exp_f32 v50, v50
    v_cvt_pk_bf16_f32 v102, v44, v45
    v_exp_f32 v51, v51
    v_exp_f32 v52, v52
    v_cvt_pk_bf16_f32 v103, v46, v47
    v_exp_f32 v53, v53
    v_exp_f32 v54, v54
    v_cvt_pk_bf16_f32 v96, v48, v49
    v_mfma_f32_32x32x16_bf16 v[80:95], v[20:23], v[100:103], v[80:95]
    v_exp_f32 v55, v55
    ds_read_b64_tr_b16 v[16:17], v114 offset:2048
    ds_read_b64_tr_b16 v[18:19], v114 offset:2176
    v_exp_f32 v56, v56
    v_cvt_pk_bf16_f32 v97, v50, v51
    ds_read_b64_tr_b16 v[20:21], v114 offset:2304
    ds_read_b64_tr_b16 v[22:23], v114 offset:2432
    v_exp_f32 v57, v57
    v_exp_f32 v58, v58
    v_cvt_pk_bf16_f32 v98, v52, v53
    s_waitcnt lgkmcnt(4)
    v_mfma_f32_32x32x16_bf16 v[32:47], v[8:11], v[4:7], v[64:79]
    v_exp_f32 v59, v59
    ds_read_b128 v[12:15], v113 offset:2560
    v_exp_f32 v60, v60
    v_cvt_pk_bf16_f32 v99, v54, v55
    s_add_u32 m0, s35, 20480
    s_add_u32 s28, s31, 20480
    buffer_load_dwordx4 v124, s[12:15], s28 offen lds
    v_exp_f32 v61, v61
    v_exp_f32 v62, v62
    v_cvt_pk_bf16_f32 v100, v56, v57
    v_mfma_f32_32x32x16_bf16 v[80:95], v[24:27], v[96:99], v[80:95]
    v_exp_f32 v63, v63
    v_exp_f32 v32, v32
    v_cvt_pk_bf16_f32 v101, v58, v59
    v_exp_f32 v33, v33
    s_add_u32 m0, s32, 24576
    s_add_u32 s28, s30, 24576
    buffer_load_dwordx4 v124, s[12:15], s28 offen lds
    v_exp_f32 v34, v34
    v_cvt_pk_bf16_f32 v102, v60, v61
    v_exp_f32 v35, v35
    v_exp_f32 v36, v36
    v_cvt_pk_bf16_f32 v103, v62, v63
    v_exp_f32 v37, v37
    v_exp_f32 v38, v38
    v_cvt_pk_bf16_f32 v96, v32, v33
    v_mfma_f32_32x32x16_bf16 v[80:95], v[28:31], v[100:103], v[80:95]
    v_exp_f32 v39, v39
    ds_read_b64_tr_b16 v[24:25], v114 offset:2560
    ds_read_b64_tr_b16 v[26:27], v114 offset:2688
    v_exp_f32 v40, v40
    v_cvt_pk_bf16_f32 v97, v34, v35
    ds_read_b64_tr_b16 v[28:29], v114 offset:2816
    ds_read_b64_tr_b16 v[30:31], v114 offset:2944
    v_exp_f32 v41, v41
    v_exp_f32 v42, v42
    v_cvt_pk_bf16_f32 v98, v36, v37
    s_waitcnt lgkmcnt(4)
    v_mfma_f32_32x32x16_bf16 v[48:63], v[12:15], v[4:7], v[64:79]
    v_exp_f32 v43, v43
    ds_read_b128 v[8:11], v113 offset:3072
    v_exp_f32 v44, v44
    v_cvt_pk_bf16_f32 v99, v38, v39
    s_add_u32 m0, s35, 24576
    s_add_u32 s28, s31, 24576
    buffer_load_dwordx4 v124, s[12:15], s28 offen lds
    v_exp_f32 v45, v45
    v_exp_f32 v46, v46
    v_cvt_pk_bf16_f32 v100, v40, v41
    v_mfma_f32_32x32x16_bf16 v[80:95], v[16:19], v[96:99], v[80:95]
    v_exp_f32 v47, v47
    v_exp_f32 v48, v48
    v_cvt_pk_bf16_f32 v101, v42, v43
    v_exp_f32 v49, v49
    s_add_u32 m0, s32, 28672
    s_add_u32 s28, s30, 28672
    buffer_load_dwordx4 v124, s[12:15], s28 offen lds
    v_exp_f32 v50, v50
    v_cvt_pk_bf16_f32 v102, v44, v45
    v_exp_f32 v51, v51
    v_exp_f32 v52, v52
    v_cvt_pk_bf16_f32 v103, v46, v47
    v_exp_f32 v53, v53
    v_exp_f32 v54, v54
    v_cvt_pk_bf16_f32 v96, v48, v49
    v_mfma_f32_32x32x16_bf16 v[80:95], v[20:23], v[100:103], v[80:95]
    v_exp_f32 v55, v55
    ds_read_b64_tr_b16 v[16:17], v114 offset:3072
    ds_read_b64_tr_b16 v[18:19], v114 offset:3200
    v_exp_f32 v56, v56
    v_cvt_pk_bf16_f32 v97, v50, v51
    ds_read_b64_tr_b16 v[20:21], v114 offset:3328
    ds_read_b64_tr_b16 v[22:23], v114 offset:3456
    v_exp_f32 v57, v57
    v_exp_f32 v58, v58
    v_cvt_pk_bf16_f32 v98, v52, v53
    s_waitcnt lgkmcnt(4)
    v_mfma_f32_32x32x16_bf16 v[32:47], v[8:11], v[4:7], v[64:79]
    v_exp_f32 v59, v59
    ds_read_b128 v[12:15], v113 offset:3584
    v_exp_f32 v60, v60
    v_cvt_pk_bf16_f32 v99, v54, v55
    s_add_u32 m0, s35, 28672
    s_add_u32 s28, s31, 28672
    buffer_load_dwordx4 v124, s[12:15], s28 offen lds
    v_exp_f32 v61, v61
    v_exp_f32 v62, v62
    v_cvt_pk_bf16_f32 v100, v56, v57
    v_mfma_f32_32x32x16_bf16 v[80:95], v[24:27], v[96:99], v[80:95]
    v_exp_f32 v63, v63
    v_exp_f32 v32, v32
    v_cvt_pk_bf16_f32 v101, v58, v59
    v_exp_f32 v33, v33
    v_exp_f32 v34, v34
    v_cvt_pk_bf16_f32 v102, v60, v61
    v_exp_f32 v35, v35
    v_exp_f32 v36, v36
    v_cvt_pk_bf16_f32 v103, v62, v63
    v_exp_f32 v37, v37
    v_exp_f32 v38, v38
    v_cvt_pk_bf16_f32 v96, v32, v33
    v_mfma_f32_32x32x16_bf16 v[80:95], v[28:31], v[100:103], v[80:95]
    v_exp_f32 v39, v39
    ds_read_b64_tr_b16 v[24:25], v114 offset:3584
    ds_read_b64_tr_b16 v[26:27], v114 offset:3712
    v_exp_f32 v40, v40
    v_cvt_pk_bf16_f32 v97, v34, v35
    ds_read_b64_tr_b16 v[28:29], v114 offset:3840
    ds_read_b64_tr_b16 v[30:31], v114 offset:3968
    v_exp_f32 v41, v41
    v_exp_f32 v42, v42
    v_cvt_pk_bf16_f32 v98, v36, v37
    s_waitcnt lgkmcnt(4)
    v_mfma_f32_32x32x16_bf16 v[48:63], v[12:15], v[4:7], v[64:79]
    v_exp_f32 v43, v43
    ds_read_b128 v[8:11], v113 offset:4096
    v_exp_f32 v44, v44
    v_cvt_pk_bf16_f32 v99, v38, v39
    v_exp_f32 v45, v45
    v_exp_f32 v46, v46
    v_cvt_pk_bf16_f32 v100, v40, v41
    v_mfma_f32_32x32x16_bf16 v[80:95], v[16:19], v[96:99], v[80:95]
    v_exp_f32 v47, v47
    v_exp_f32 v48, v48
    v_cvt_pk_bf16_f32 v101, v42, v43
    v_exp_f32 v49, v49
    v_exp_f32 v50, v50
    v_cvt_pk_bf16_f32 v102, v44, v45
    v_exp_f32 v51, v51
    v_exp_f32 v52, v52
    v_cvt_pk_bf16_f32 v103, v46, v47
    v_exp_f32 v53, v53
    v_exp_f32 v54, v54
    v_cvt_pk_bf16_f32 v96, v48, v49
    v_mfma_f32_32x32x16_bf16 v[80:95], v[20:23], v[100:103], v[80:95]
    v_exp_f32 v55, v55
    ds_read_b64_tr_b16 v[16:17], v114 offset:4096
    ds_read_b64_tr_b16 v[18:19], v114 offset:4224
    v_exp_f32 v56, v56
    v_cvt_pk_bf16_f32 v97, v50, v51
    ds_read_b64_tr_b16 v[20:21], v114 offset:4352
    ds_read_b64_tr_b16 v[22:23], v114 offset:4480
    v_exp_f32 v57, v57
    v_exp_f32 v58, v58
    v_cvt_pk_bf16_f32 v98, v52, v53
    s_waitcnt lgkmcnt(4)
    v_mfma_f32_32x32x16_bf16 v[32:47], v[8:11], v[4:7], v[64:79]
    v_exp_f32 v59, v59
    ds_read_b128 v[12:15], v113 offset:4608
    v_exp_f32 v60, v60
    v_cvt_pk_bf16_f32 v99, v54, v55
    v_exp_f32 v61, v61
    v_exp_f32 v62, v62
    v_cvt_pk_bf16_f32 v100, v56, v57
    v_mfma_f32_32x32x16_bf16 v[80:95], v[24:27], v[96:99], v[80:95]
    v_exp_f32 v63, v63
    s_waitcnt vmcnt(0)
    s_barrier
    s_mov_b32 s33, 1
LB_chunk:
    v_add_u32 v113, 4096, v113
    v_add_u32 v114, v115, v114
    v_exp_f32 v32, v32
    v_cvt_pk_bf16_f32 v101, v58, v59
    v_exp_f32 v33, v33
    v_exp_f32 v34, v34
    v_cvt_pk_bf16_f32 v102, v60, v61
    v_exp_f32 v35, v35
    v_exp_f32 v36, v36
    v_cvt_pk_bf16_f32 v103, v62, v63
    v_exp_f32 v37, v37
    v_exp_f32 v38, v38
    v_cvt_pk_bf16_f32 v96, v32, v33
    v_mfma_f32_32x32x16_bf16 v[80:95], v[28:31], v[100:103], v[80:95]
    v_exp_f32 v39, v39
    ds_read_b64_tr_b16 v[24:25], v114 offset:512
    ds_read_b64_tr_b16 v[26:27], v114 offset:640
    v_exp_f32 v40, v40
    v_cvt_pk_bf16_f32 v97, v34, v35
    ds_read_b64_tr_b16 v[28:29], v114 offset:768
    ds_read_b64_tr_b16 v[30:31], v114 offset:896
    v_exp_f32 v41, v41
    v_exp_f32 v42, v42
    v_cvt_pk_bf16_f32 v98, v36, v37
    s_waitcnt lgkmcnt(4)
    v_mfma_f32_32x32x16_bf16 v[48:63], v[12:15], v[4:7], v[64:79]
    v_exp_f32 v43, v43
    ds_read_b128 v[8:11], v113 offset:1024
    v_exp_f32 v44, v44
    v_cvt_pk_bf16_f32 v99, v38, v39
    v_exp_f32 v45, v45
    v_exp_f32 v46, v46
    v_cvt_pk_bf16_f32 v100, v40, v41
    v_mfma_f32_32x32x16_bf16 v[80:95], v[16:19], v[96:99], v[80:95]
    v_exp_f32 v47, v47
    v_exp_f32 v48, v48
    v_cvt_pk_bf16_f32 v101, v42, v43
    v_exp_f32 v49, v49
    v_exp_f32 v50, v50
    v_cvt_pk_bf16_f32 v102, v44, v45
    v_exp_f32 v51, v51
    v_exp_f32 v52, v52
    v_cvt_pk_bf16_f32 v103, v46, v47
    v_exp_f32 v53, v53
    v_exp_f32 v54, v54
    v_cvt_pk_bf16_f32 v96, v48, v49
    v_mfma_f32_32x32x16_bf16 v[80:95], v[20:23], v[100:103], v[80:95]
    v_exp_f32 v55, v55
    ds_read_b64_tr_b16 v[16:17], v114 offset:1024
    ds_read_b64_tr_b16 v[18:19], v114 offset:1152
    v_exp_f32 v56, v56
    v_cvt_pk_bf16_f32 v97, v50, v51
    ds_read_b64_tr_b16 v[20:21], v114 offset:1280
    ds_read_b64_tr_b16 v[22:23], v114 offset:1408
    v_exp_f32 v57, v57
    v_exp_f32 v58, v58
    v_cvt_pk_bf16_f32 v98, v52, v53
    s_waitcnt lgkmcnt(4)
    v_mfma_f32_32x32x16_bf16 v[32:47], v[8:11], v[4:7], v[64:79]
    v_exp_f32 v59, v59
    ds_read_b128 v[12:15], v113 offset:1536
    v_exp_f32 v60, v60
    v_cvt_pk_bf16_f32 v99, v54, v55
    v_exp_f32 v61, v61
    v_exp_f32 v62, v62
    v_cvt_pk_bf16_f32 v100, v56, v57
    v_mfma_f32_32x32x16_bf16 v[80:95], v[24:27], v[96:99], v[80:95]
    v_exp_f32 v63, v63
    v_exp_f32 v32, v32
    v_cvt_pk_bf16_f32 v101, v58, v59
    v_exp_f32 v33, v33
    v_exp_f32 v34, v34
    v_cvt_pk_bf16_f32 v102, v60, v61
    v_exp_f32 v35, v35
    v_exp_f32 v36, v36
    v_cvt_pk_bf16_f32 v103, v62, v63
    v_exp_f32 v37, v37
    v_exp_f32 v38, v38
    v_cvt_pk_bf16_f32 v96, v32, v33
    v_mfma_f32_32x32x16_bf16 v[80:95], v[28:31], v[100:103], v[80:95]
    v_exp_f32 v39, v39
    ds_read_b64_tr_b16 v[24:25], v114 offset:1536
    ds_read_b64_tr_b16 v[26:27], v114 offset:1664
    v_exp_f32 v40, v40
    v_cvt_pk_bf16_f32 v97, v34, v35
    ds_read_b64_tr_b16 v[28:29], v114 offset:1792
    ds_read_b64_tr_b16 v[30:31], v114 offset:1920
    v_exp_f32 v41, v41
    v_exp_f32 v42, v42
    v_cvt_pk_bf16_f32 v98, v36, v37
    s_waitcnt lgkmcnt(4)
    v_mfma_f32_32x32x16_bf16 v[48:63], v[12:15], v[4:7], v[64:79]
    v_exp_f32 v43, v43
    ds_read_b128 v[8:11], v113 offset:2048
    v_exp_f32 v44, v44
    v_cvt_pk_bf16_f32 v99, v38, v39
    v_exp_f32 v45, v45
    v_exp_f32 v46, v46
    v_cvt_pk_bf16_f32 v100, v40, v41
    v_mfma_f32_32x32x16_bf16 v[80:95], v[16:19], v[96:99], v[80:95]
    v_exp_f32 v47, v47
    v_exp_f32 v48, v48
    v_cvt_pk_bf16_f32 v101, v42, v43
    v_exp_f32 v49, v49
    v_exp_f32 v50, v50
    v_cvt_pk_bf16_f32 v102, v44, v45
    v_exp_f32 v51, v51
    v_exp_f32 v52, v52
    v_cvt_pk_bf16_f32 v103, v46, v47
    v_exp_f32 v53, v53
    v_exp_f32 v54, v54
    v_cvt_pk_bf16_f32 v96, v48, v49
    v_mfma_f32_32x32x16_bf16 v[80:95], v[20:23], v[100:103], v[80:95]
    v_exp_f32 v55, v55
    ds_read_b64_tr_b16 v[16:17], v114 offset:2048
    ds_read_b64_tr_b16 v[18:19], v114 offset:2176
    v_exp_f32 v56, v56
    v_cvt_pk_bf16_f32 v97, v50, v51
    ds_read_b64_tr_b16 v[20:21], v114 offset:2304
    ds_read_b64_tr_b16 v[22:23], v114 offset:2432
    v_exp_f32 v57, v57
    v_exp_f32 v58, v58
    v_cvt_pk_bf16_f32 v98, v52, v53
    s_waitcnt lgkmcnt(4)
    v_mfma_f32_32x32x16_bf16 v[32:47], v[8:11], v[4:7], v[64:79]
    v_exp_f32 v59, v59
    ds_read_b128 v[12:15], v113 offset:2560
    v_exp_f32 v60, v60
    v_cvt_pk_bf16_f32 v99, v54, v55
    v_exp_f32 v61, v61
    v_exp_f32 v62, v62
    v_cvt_pk_bf16_f32 v100, v56, v57
    v_mfma_f32_32x32x16_bf16 v[80:95], v[24:27], v[96:99], v[80:95]
    v_exp_f32 v63, v63
    v_exp_f32 v32, v32
    v_cvt_pk_bf16_f32 v101, v58, v59
    v_exp_f32 v33, v33
    v_exp_f32 v34, v34
    v_cvt_pk_bf16_f32 v102, v60, v61
    v_exp_f32 v35, v35
    v_exp_f32 v36, v36
    v_cvt_pk_bf16_f32 v103, v62, v63
    v_exp_f32 v37, v37
    v_exp_f32 v38, v38
    v_cvt_pk_bf16_f32 v96, v32, v33
    v_mfma_f32_32x32x16_bf16 v[80:95], v[28:31], v[100:103], v[80:95]
    v_exp_f32 v39, v39
    ds_read_b64_tr_b16 v[24:25], v114 offset:2560
    ds_read_b64_tr_b16 v[26:27], v114 offset:2688
    v_exp_f32 v40, v40
    v_cvt_pk_bf16_f32 v97, v34, v35
    ds_read_b64_tr_b16 v[28:29], v114 offset:2816
    ds_read_b64_tr_b16 v[30:31], v114 offset:2944
    v_exp_f32 v41, v41
    v_exp_f32 v42, v42
    v_cvt_pk_bf16_f32 v98, v36, v37
    s_waitcnt lgkmcnt(4)
    v_mfma_f32_32x32x16_bf16 v[48:63], v[12:15], v[4:7], v[64:79]
    v_exp_f32 v43, v43
    ds_read_b128 v[8:11], v113 offset:3072
    v_exp_f32 v44, v44
    v_cvt_pk_bf16_f32 v99, v38, v39
    v_exp_f32 v45, v45
    v_exp_f32 v46, v46
    v_cvt_pk_bf16_f32 v100, v40, v41
    v_mfma_f32_32x32x16_bf16 v[80:95], v[16:19], v[96:99], v[80:95]
    v_exp_f32 v47, v47
    v_exp_f32 v48, v48
    v_cvt_pk_bf16_f32 v101, v42, v43
    v_exp_f32 v49, v49
    v_exp_f32 v50, v50
    v_cvt_pk_bf16_f32 v102, v44, v45
    v_exp_f32 v51, v51
    v_exp_f32 v52, v52
    v_cvt_pk_bf16_f32 v103, v46, v47
    v_exp_f32 v53, v53
    v_exp_f32 v54, v54
    v_cvt_pk_bf16_f32 v96, v48, v49
    v_mfma_f32_32x32x16_bf16 v[80:95], v[20:23], v[100:103], v[80:95]
    v_exp_f32 v55, v55
    ds_read_b64_tr_b16 v[16:17], v114 offset:3072
    ds_read_b64_tr_b16 v[18:19], v114 offset:3200
    v_exp_f32 v56, v56
    v_cvt_pk_bf16_f32 v97, v50, v51
    ds_read_b64_tr_b16 v[20:21], v114 offset:3328
    ds_read_b64_tr_b16 v[22:23], v114 offset:3456
    v_exp_f32 v57, v57
    v_exp_f32 v58, v58
    v_cvt_pk_bf16_f32 v98, v52, v53
    s_waitcnt lgkmcnt(4)
    v_mfma_f32_32x32x16_bf16 v[32:47], v[8:11], v[4:7], v[64:79]
    v_exp_f32 v59, v59
    ds_read_b128 v[12:15], v113 offset:3584
    v_exp_f32 v60, v60
    v_cvt_pk_bf16_f32 v99, v54, v55
    v_exp_f32 v61, v61
    v_exp_f32 v62, v62
    v_cvt_pk_bf16_f32 v100, v56, v57
    v_mfma_f32_32x32x16_bf16 v[80:95], v[24:27], v[96:99], v[80:95]
    v_exp_f32 v63, v63
    v_exp_f32 v32, v32
    v_cvt_pk_bf16_f32 v101, v58, v59
    v_exp_f32 v33, v33
    v_exp_f32 v34, v34
    v_cvt_pk_bf16_f32 v102, v60, v61
    v_exp_f32 v35, v35
    v_exp_f32 v36, v36
    v_cvt_pk_bf16_f32 v103, v62, v63
    v_exp_f32 v37, v37
    v_exp_f32 v38, v38
    v_cvt_pk_bf16_f32 v96, v32, v33
    v_mfma_f32_32x32x16_bf16 v[80:95], v[28:31], v[100:103], v[80:95]
    v_exp_f32 v39, v39
    ds_read_b64_tr_b16 v[24:25], v114 offset:3584
    ds_read_b64_tr_b16 v[26:27], v114 offset:3712
    v_exp_f32 v40, v40
    v_cvt_pk_bf16_f32 v97, v34, v35
    ds_read_b64_tr_b16 v[28:29], v114 offset:3840
    ds_read_b64_tr_b16 v[30:31], v114 offset:3968
    v_exp_f32 v41, v41
    v_exp_f32 v42, v42
    v_cvt_pk_bf16_f32 v98, v36, v37
    s_waitcnt lgkmcnt(4)
    v_mfma_f32_32x32x16_bf16 v[48:63], v[12:15], v[4:7], v[64:79]
    v_exp_f32 v43, v43
    ds_read_b128 v[8:11], v113 offset:4096
    v_exp_f32 v44, v44
    v_cvt_pk_bf16_f32 v99, v38, v39
    v_exp_f32 v45, v45
    v_exp_f32 v46, v46
    v_cvt_pk_bf16_f32 v100, v40, v41
    v_mfma_f32_32x32x16_bf16 v[80:95], v[16:19], v[96:99], v[80:95]
    v_exp_f32 v47, v47
    v_exp_f32 v48, v48
    v_cvt_pk_bf16_f32 v101, v42, v43
    v_exp_f32 v49, v49
    v_exp_f32 v50, v50
    v_cvt_pk_bf16_f32 v102, v44, v45
    v_exp_f32 v51, v51
    v_exp_f32 v52, v52
    v_cvt_pk_bf16_f32 v103, v46, v47
    v_exp_f32 v53, v53
    v_exp_f32 v54, v54
    v_cvt_pk_bf16_f32 v96, v48, v49
    v_mfma_f32_32x32x16_bf16 v[80:95], v[20:23], v[100:103], v[80:95]
    v_exp_f32 v55, v55
    ds_read_b64_tr_b16 v[16:17], v114 offset:4096
    ds_read_b64_tr_b16 v[18:19], v114 offset:4224
    v_exp_f32 v56, v56
    v_cvt_pk_bf16_f32 v97, v50, v51
    ds_read_b64_tr_b16 v[20:21], v114 offset:4352
    ds_read_b64_tr_b16 v[22:23], v114 offset:4480
    v_exp_f32 v57, v57
    v_exp_f32 v58, v58
    v_cvt_pk_bf16_f32 v98, v52, v53
    s_waitcnt lgkmcnt(4)
    v_mfma_f32_32x32x16_bf16 v[32:47], v[8:11], v[4:7], v[64:79]
    v_exp_f32 v59, v59
    ds_read_b128 v[12:15], v113 offset:4608
    v_exp_f32 v60, v60
    v_cvt_pk_bf16_f32 v99, v54, v55
    v_exp_f32 v61, v61
    v_exp_f32 v62, v62
    v_cvt_pk_bf16_f32 v100, v56, v57
    v_mfma_f32_32x32x16_bf16 v[80:95], v[24:27], v[96:99], v[80:95]
    v_exp_f32 v63, v63
    s_add_u32 s33, s33, 1
    s_cmp_lt_u32 s33, 8
    s_cbranch_scc1 LB_chunk
    s_nop 0
    v_cvt_pk_bf16_f32 v101, v58, v59
    v_cvt_pk_bf16_f32 v102, v60, v61
    v_cvt_pk_bf16_f32 v103, v62, v63
    s_nop 1
    v_mfma_f32_32x32x16_bf16 v[80:95], v[28:31], v[100:103], v[80:95]
    s_waitcnt lgkmcnt(0)
    s_nop 15
    v_cmp_nge_f32 vcc, s34, v88
    s_cbranch_vccnz LB_slow
LB_next:
    v_rcp_f32 v118, v88
    s_nop 0
    v_mul_f32 v80, v80, v118
    v_mul_f32 v81, v81, v118
    v_mul_f32 v82, v82, v118
    v_mul_f32 v83, v83, v118
    v_mul_f32 v84, v84, v118
    v_mul_f32 v85, v85, v118
    v_mul_f32 v86, v86, v118
    v_mul_f32 v87, v87, v118
    v_cvt_pk_bf16_f32 v96, v80, v81
    v_cvt_pk_bf16_f32 v97, v82, v83
    v_cvt_pk_bf16_f32 v98, v84, v85
    v_cvt_pk_bf16_f32 v99, v86, v87
    v_lshlrev_b32 v118, 4, v125
    v_lshl_add_u32 v118, v3, 15, v118
    v_permlane32_swap_b32 v96, v98
    v_permlane32_swap_b32 v97, v99
    s_lshl_b32 s29, s24, 16
    buffer_store_dwordx4 v[96:99], v118, s[20:23], s29 offen sc1
LB_exit:
    s_endpgm
LB_slow:
    v_mov_b32 v80, 0
    v_mov_b32 v81, 0
    v_mov_b32 v82, 0
    v_mov_b32 v83, 0
    v_mov_b32 v84, 0
    v_mov_b32 v85, 0
    v_mov_b32 v86, 0
    v_mov_b32 v87, 0
    v_mov_b32 v88, 0
    v_mov_b32 v89, 0
    v_mov_b32 v90, 0
    v_mov_b32 v91, 0
    v_mov_b32 v92, 0
    v_mov_b32 v93, 0
    v_mov_b32 v94, 0
    v_mov_b32 v95, 0
    v_lshrrev_b32 v115, 3, v115
    s_mov_b32 s35, 0
LB_slow_loop:
    ds_read_b128 v[8:11], v116 offset:0
    ds_read_b64_tr_b16 v[16:17], v117 offset:0
    ds_read_b64_tr_b16 v[18:19], v117 offset:128
    ds_read_b64_tr_b16 v[20:21], v117 offset:256
    ds_read_b64_tr_b16 v[22:23], v117 offset:384
    s_waitcnt lgkmcnt(0)
    v_mfma_f32_32x32x16_bf16 v[32:47], v[8:11], v[4:7], v[64:79]
    s_nop 15
    v_max3_f32 v118, v32, v33, v34
    v_max3_f32 v118, v118, v35, v36
    v_max3_f32 v118, v118, v37, v38
    v_max3_f32 v118, v118, v39, v40
    v_max3_f32 v118, v118, v41, v42
    v_max3_f32 v118, v118, v43, v44
    v_max3_f32 v118, v118, v45, v46
    v_max_f32 v118, v118, v47
    v_mov_b32 v119, v118
    s_nop 1
    v_permlane32_swap_b32 v118, v119
    s_nop 1
    v_max_f32 v118, v118, v119
    v_add_f32 v118, 0x42a00000, v118
    v_max_f32 v118, 0, v118
    v_sub_f32 v64, v64, v118
    v_sub_f32 v32, v32, v118
    v_sub_f32 v65, v65, v118
    v_sub_f32 v33, v33, v118
    v_sub_f32 v66, v66, v118
    v_sub_f32 v34, v34, v118
    v_sub_f32 v67, v67, v118
    v_sub_f32 v35, v35, v118
    v_sub_f32 v68, v68, v118
    v_sub_f32 v36, v36, v118
    v_sub_f32 v69, v69, v118
    v_sub_f32 v37, v37, v118
    v_sub_f32 v70, v70, v118
    v_sub_f32 v38, v38, v118
    v_sub_f32 v71, v71, v118
    v_sub_f32 v39, v39, v118
    v_sub_f32 v72, v72, v118
    v_sub_f32 v40, v40, v118
    v_sub_f32 v73, v73, v118
    v_sub_f32 v41, v41, v118
    v_sub_f32 v74, v74, v118
    v_sub_f32 v42, v42, v118
    v_sub_f32 v75, v75, v118
    v_sub_f32 v43, v43, v118
    v_sub_f32 v76, v76, v118
    v_sub_f32 v44, v44, v118
    v_sub_f32 v77, v77, v118
    v_sub_f32 v45, v45, v118
    v_sub_f32 v78, v78, v118
    v_sub_f32 v46, v46, v118
    v_sub_f32 v79, v79, v118
    v_sub_f32 v47, v47, v118
    v_sub_f32 v118, 0, v118
    v_exp_f32 v118, v118
    s_nop 0
    v_mul_f32 v80, v80, v118
    v_mul_f32 v81, v81, v118
    v_mul_f32 v82, v82, v118
    v_mul_f32 v83, v83, v118
    v_mul_f32 v84, v84, v118
    v_mul_f32 v85, v85, v118
    v_mul_f32 v86, v86, v118
    v_mul_f32 v87, v87, v118
    v_mul_f32 v88, v88, v118
    v_exp_f32 v32, v32
    v_exp_f32 v33, v33
    v_exp_f32 v34, v34
    v_exp_f32 v35, v35
    v_cvt_pk_bf16_f32 v96, v32, v33
    v_exp_f32 v36, v36
    v_exp_f32 v37, v37
    v_cvt_pk_bf16_f32 v97, v34, v35
    v_exp_f32 v38, v38
    v_exp_f32 v39, v39
    v_cvt_pk_bf16_f32 v98, v36, v37
    s_nop 0
    v_cvt_pk_bf16_f32 v99, v38, v39
    v_exp_f32 v40, v40
    v_exp_f32 v41, v41
    v_exp_f32 v42, v42
    v_exp_f32 v43, v43
    v_cvt_pk_bf16_f32 v100, v40, v41
    v_exp_f32 v44, v44
    v_exp_f32 v45, v45
    v_cvt_pk_bf16_f32 v101, v42, v43
    v_exp_f32 v46, v46
    v_exp_f32 v47, v47
    v_cvt_pk_bf16_f32 v102, v44, v45
    s_nop 0
    v_cvt_pk_bf16_f32 v103, v46, v47
    s_nop 1
    v_mfma_f32_32x32x16_bf16 v[80:95], v[16:19], v[96:99], v[80:95]
    v_mfma_f32_32x32x16_bf16 v[80:95], v[20:23], v[100:103], v[80:95]
    s_nop 15
    v_add_u32 v116, 512, v116
    v_add_u32 v117, v115, v117
    s_add_u32 s35, s35, 1
    s_cmp_lt_u32 s35, 64
    s_cbranch_scc1 LB_slow_loop
    s_branch LB_next
LB_gemm:
    s_load_dwordx2 s[4:5], s[0:1], 0
    s_add_u32 s12, s10, 20971520
    s_addc_u32 s13, s11, 0
    s_mov_b32 s14, 2359296
    s_mov_b32 s15, 0x00020000
    s_add_u32 s16, s10, 25165824
    s_addc_u32 s17, s11, 0
    s_mov_b32 s18, 4194304
    s_mov_b32 s19, 0x00020000
    s_add_u32 s20, s10, 8388608
    s_addc_u32 s21, s11, 0
    s_mov_b32 s22, 9437184
    s_mov_b32 s23, 0x00020000
    s_and_b32 s27, s26, 1
    s_lshl_b32 s27, s27, 5
    s_lshl_b32 s28, s24, 6
    s_add_u32 s27, s27, s28
    v_add_u32 v7, s27, v2
    v_lshlrev_b32 v5, 4, v7
    v_lshl_add_u32 v5, v3, 15, v5
    s_bfe_u32 s27, s26, 0x10001
    s_lshl_b32 s27, s27, 5
    s_lshl_b32 s28, s25, 6
    s_add_u32 s27, s27, s28
    v_add_u32 v4, s27, v2
    v_lshlrev_b32 v4, 4, v4
    v_lshl_add_u32 v4, v3, 13, v4
    v_lshlrev_b32 v6, 10, v7
    v_lshl_add_u32 v6, v3, 3, v6
    s_lshl_b32 s27, s27, 1
    v_xor_b32 v2, 512, v4
    v_xor_b32 v3, 512, v5
    s_sub_u32 s36, s26, 8
    s_mul_i32 s28, s36, 458752
    s_add_u32 s28, s28, 524288
    s_mul_i32 s29, s36, 1835008
    s_add_u32 s29, s29, 2097152
    s_lshl_b32 s38, s36, 3
    s_add_u32 s38, s38, 155904
    v_mov_b32 v7, s38
    v_mov_b32 v8, 0
    v_mov_b32 v9, 0
    ds_write_b64 v7, v[8:9]
    s_waitcnt lgkmcnt(0)
    s_barrier
    s_barrier
    buffer_load_dwordx4 v[80:83], v4, s[12:15], s28 offen
    buffer_load_dwordx4 v[84:87], v5, s[20:23], s29 offen
    buffer_load_dwordx4 v[88:91], v2, s[12:15], s28 offen
    buffer_load_dwordx4 v[92:95], v3, s[20:23], s29 offen
    s_add_u32 s28, s28, 16384
    s_add_u32 s29, s29, 65536
    buffer_load_dwordx4 v[96:99], v4, s[12:15], s28 offen
    buffer_load_dwordx4 v[100:103], v5, s[20:23], s29 offen
    buffer_load_dwordx4 v[104:107], v2, s[12:15], s28 offen
    buffer_load_dwordx4 v[108:111], v3, s[20:23], s29 offen
    s_add_u32 s28, s28, 16384
    s_add_u32 s29, s29, 65536
    buffer_load_dwordx4 v[112:115], v4, s[12:15], s28 offen
    buffer_load_dwordx4 v[116:119], v5, s[20:23], s29 offen
    buffer_load_dwordx4 v[120:123], v2, s[12:15], s28 offen
    buffer_load_dwordx4 v[124:127], v3, s[20:23], s29 offen
    s_add_u32 s28, s28, 16384
    s_add_u32 s29, s29, 65536
    buffer_load_dwordx4 v[128:131], v4, s[12:15], s28 offen
    buffer_load_dwordx4 v[132:135], v5, s[20:23], s29 offen
    buffer_load_dwordx4 v[136:139], v2, s[12:15], s28 offen
    buffer_load_dwordx4 v[140:143], v3, s[20:23], s29 offen
    s_add_u32 s28, s28, 16384
    s_add_u32 s29, s29, 65536
    s_mov_b32 s40, s4
    s_mov_b32 s41, s5
    s_mov_b32 s42, 2097152
    s_mov_b32 s43, 0x00020000
    buffer_load_dwordx2 v[8:9], v6, s[40:43], s27 offen offset:0
    buffer_load_dwordx2 v[10:11], v6, s[40:43], s27 offen offset:16
    buffer_load_dwordx2 v[12:13], v6, s[40:43], s27 offen offset:32
    buffer_load_dwordx2 v[14:15], v6, s[40:43], s27 offen offset:48
    v_mov_b32 v32, 0
    v_mov_b32 v33, 0
    v_mov_b32 v34, 0
    v_mov_b32 v35, 0
    v_mov_b32 v36, 0
    v_mov_b32 v37, 0
    v_mov_b32 v38, 0
    v_mov_b32 v39, 0
    v_mov_b32 v40, 0
    v_mov_b32 v41, 0
    v_mov_b32 v42, 0
    v_mov_b32 v43, 0
    v_mov_b32 v44, 0
    v_mov_b32 v45, 0
    v_mov_b32 v46, 0
    v_mov_b32 v47, 0
    v_mov_b32 v48, 0
    v_mov_b32 v49, 0
    v_mov_b32 v50, 0
    v_mov_b32 v51, 0
    v_mov_b32 v52, 0
    v_mov_b32 v53, 0
    v_mov_b32 v54, 0
    v_mov_b32 v55, 0
    v_mov_b32 v56, 0
    v_mov_b32 v57, 0
    v_mov_b32 v58, 0
    v_mov_b32 v59, 0
    v_mov_b32 v60, 0
    v_mov_b32 v61, 0
    v_mov_b32 v62, 0
    v_mov_b32 v63, 0
    v_mov_b32 v64, 0
    v_mov_b32 v65, 0
    v_mov_b32 v66, 0
    v_mov_b32 v67, 0
    v_mov_b32 v68, 0
    v_mov_b32 v69, 0
    v_mov_b32 v70, 0
    v_mov_b32 v71, 0
    v_mov_b32 v72, 0
    v_mov_b32 v73, 0
    v_mov_b32 v74, 0
    v_mov_b32 v75, 0
    v_mov_b32 v76, 0
    v_mov_b32 v77, 0
    v_mov_b32 v78, 0
    v_mov_b32 v79, 0
    s_waitcnt vmcnt(0)
    v_lshlrev_b32 v16, 16, v8
    v_and_b32 v17, 0xffff0000, v8
    v_lshlrev_b32 v18, 16, v9
    v_and_b32 v19, 0xffff0000, v9
    v_lshlrev_b32 v20, 16, v10
    v_and_b32 v21, 0xffff0000, v10
    v_lshlrev_b32 v22, 16, v11
    v_and_b32 v23, 0xffff0000, v11
    v_lshlrev_b32 v24, 16, v12
    v_and_b32 v25, 0xffff0000, v12
    v_lshlrev_b32 v26, 16, v13
    v_and_b32 v27, 0xffff0000, v13
    v_lshlrev_b32 v28, 16, v14
    v_and_b32 v29, 0xffff0000, v14
    v_lshlrev_b32 v30, 16, v15
    v_and_b32 v31, 0xffff0000, v15
    s_mov_b32 s33, 0
LB_gloop:
    s_waitcnt vmcnt(12)
    v_mfma_f32_32x32x16_bf16 v[16:31], v[80:83], v[84:87], v[16:31]
    v_mfma_f32_32x32x16_bf16 v[32:47], v[80:83], v[92:95], v[32:47]
    v_mfma_f32_32x32x16_bf16 v[48:63], v[88:91], v[84:87], v[48:63]
    v_mfma_f32_32x32x16_bf16 v[64:79], v[88:91], v[92:95], v[64:79]
    buffer_load_dwordx4 v[80:83], v4, s[12:15], s28 offen
    buffer_load_dwordx4 v[84:87], v5, s[20:23], s29 offen
    buffer_load_dwordx4 v[88:91], v2, s[12:15], s28 offen
    buffer_load_dwordx4 v[92:95], v3, s[20:23], s29 offen
    s_add_u32 s28, s28, 16384
    s_add_u32 s29, s29, 65536
    s_waitcnt vmcnt(12)
    v_mfma_f32_32x32x16_bf16 v[16:31], v[96:99], v[100:103], v[16:31]
    v_mfma_f32_32x32x16_bf16 v[32:47], v[96:99], v[108:111], v[32:47]
    v_mfma_f32_32x32x16_bf16 v[48:63], v[104:107], v[100:103], v[48:63]
    v_mfma_f32_32x32x16_bf16 v[64:79], v[104:107], v[108:111], v[64:79]
    buffer_load_dwordx4 v[96:99], v4, s[12:15], s28 offen
    buffer_load_dwordx4 v[100:103], v5, s[20:23], s29 offen
    buffer_load_dwordx4 v[104:107], v2, s[12:15], s28 offen
    buffer_load_dwordx4 v[108:111], v3, s[20:23], s29 offen
    s_add_u32 s28, s28, 16384
    s_add_u32 s29, s29, 65536
    s_waitcnt vmcnt(12)
    v_mfma_f32_32x32x16_bf16 v[16:31], v[112:115], v[116:119], v[16:31]
    v_mfma_f32_32x32x16_bf16 v[32:47], v[112:115], v[124:127], v[32:47]
    v_mfma_f32_32x32x16_bf16 v[48:63], v[120:123], v[116:119], v[48:63]
    v_mfma_f32_32x32x16_bf16 v[64:79], v[120:123], v[124:127], v[64:79]
    buffer_load_dwordx4 v[112:115], v4, s[12:15], s28 offen
    buffer_load_dwordx4 v[116:119], v5, s[20:23], s29 offen
    buffer_load_dwordx4 v[120:123], v2, s[12:15], s28 offen
    buffer_load_dwordx4 v[124:127], v3, s[20:23], s29 offen
    s_add_u32 s28, s28, 16384
    s_add_u32 s29, s29, 65536
    s_waitcnt vmcnt(12)
    v_mfma_f32_32x32x16_bf16 v[16:31], v[128:131], v[132:135], v[16:31]
    v_mfma_f32_32x32x16_bf16 v[32:47], v[128:131], v[140:143], v[32:47]
    v_mfma_f32_32x32x16_bf16 v[48:63], v[136:139], v[132:135], v[48:63]
    v_mfma_f32_32x32x16_bf16 v[64:79], v[136:139], v[140:143], v[64:79]
    buffer_load_dwordx4 v[128:131], v4, s[12:15], s28 offen
    buffer_load_dwordx4 v[132:135], v5, s[20:23], s29 offen
    buffer_load_dwordx4 v[136:139], v2, s[12:15], s28 offen
    buffer_load_dwordx4 v[140:143], v3, s[20:23], s29 offen
    s_add_u32 s28, s28, 16384
    s_add_u32 s29, s29, 65536
    s_add_u32 s33, s33, 1
    s_cmp_lt_u32 s33, 6
    s_cbranch_scc1 LB_gloop
    s_waitcnt vmcnt(12)
    v_mfma_f32_32x32x16_bf16 v[16:31], v[80:83], v[84:87], v[16:31]
    v_mfma_f32_32x32x16_bf16 v[32:47], v[80:83], v[92:95], v[32:47]
    v_mfma_f32_32x32x16_bf16 v[48:63], v[88:91], v[84:87], v[48:63]
    v_mfma_f32_32x32x16_bf16 v[64:79], v[88:91], v[92:95], v[64:79]
    s_waitcnt vmcnt(8)
    v_mfma_f32_32x32x16_bf16 v[16:31], v[96:99], v[100:103], v[16:31]
    v_mfma_f32_32x32x16_bf16 v[32:47], v[96:99], v[108:111], v[32:47]
    v_mfma_f32_32x32x16_bf16 v[48:63], v[104:107], v[100:103], v[48:63]
    v_mfma_f32_32x32x16_bf16 v[64:79], v[104:107], v[108:111], v[64:79]
    s_waitcnt vmcnt(4)
    v_mfma_f32_32x32x16_bf16 v[16:31], v[112:115], v[116:119], v[16:31]
    v_mfma_f32_32x32x16_bf16 v[32:47], v[112:115], v[124:127], v[32:47]
    v_mfma_f32_32x32x16_bf16 v[48:63], v[120:123], v[116:119], v[48:63]
    v_mfma_f32_32x32x16_bf16 v[64:79], v[120:123], v[124:127], v[64:79]
    s_waitcnt vmcnt(0)
    v_mfma_f32_32x32x16_bf16 v[16:31], v[128:131], v[132:135], v[16:31]
    v_mfma_f32_32x32x16_bf16 v[32:47], v[128:131], v[140:143], v[32:47]
    v_mfma_f32_32x32x16_bf16 v[48:63], v[136:139], v[132:135], v[48:63]
    v_mfma_f32_32x32x16_bf16 v[64:79], v[136:139], v[140:143], v[64:79]
    s_lshl_b32 s39, s36, 12
    s_add_u32 s39, s39, 139520
    v_lshlrev_b32 v8, 4, v1
    v_add_u32 v8, s39, v8
    s_nop 15
    s_nop 3
    ds_write_b128 v8, v[32:35] offset:0
    ds_write_b128 v8, v[36:39] offset:1024
    ds_write_b128 v8, v[40:43] offset:2048
    ds_write_b128 v8, v[44:47] offset:3072
    v_mov_b32 v12, 1
    s_waitcnt lgkmcnt(0)
    ds_write_b32 v7, v12
    v_xor_b32 v10, 8, v7
LB_gw1:
    ds_read_b32 v11, v10 offset:0
    s_waitcnt lgkmcnt(0)
    v_readfirstlane_b32 s37, v11
    s_cmp_ge_u32 s37, 1
    s_cbranch_scc1 LB_gw1_ok
    s_sleep 1
    s_branch LB_gw1
LB_gw1_ok:
    s_xor_b32 s37, s36, 1
    s_lshl_b32 s37, s37, 12
    s_add_u32 s37, s37, 139520
    v_lshlrev_b32 v9, 4, v1
    v_add_u32 v9, s37, v9
    ds_read_b128 v[80:83], v9 offset:0
    ds_read_b128 v[84:87], v9 offset:1024
    ds_read_b128 v[88:91], v9 offset:2048
    ds_read_b128 v[92:95], v9 offset:3072
    s_waitcnt lgkmcnt(0)
    ds_write_b32 v7, v12 offset:4
    v_add_f32 v16, v16, v80
    v_add_f32 v17, v17, v81
    v_add_f32 v18, v18, v82
    v_add_f32 v19, v19, v83
    v_add_f32 v20, v20, v84
    v_add_f32 v21, v21, v85
    v_add_f32 v22, v22, v86
    v_add_f32 v23, v23, v87
    v_add_f32 v24, v24, v88
    v_add_f32 v25, v25, v89
    v_add_f32 v26, v26, v90
    v_add_f32 v27, v27, v91
    v_add_f32 v28, v28, v92
    v_add_f32 v29, v29, v93
    v_add_f32 v30, v30, v94
    v_add_f32 v31, v31, v95
    v_xor_b32 v10, 8, v7
LB_gc2:
    ds_read_b32 v11, v10 offset:4
    s_waitcnt lgkmcnt(0)
    v_readfirstlane_b32 s37, v11
    s_cmp_ge_u32 s37, 1
    s_cbranch_scc1 LB_gc2_ok
    s_sleep 1
    s_branch LB_gc2
LB_gc2_ok:
    ds_write_b128 v8, v[48:51] offset:0
    ds_write_b128 v8, v[52:55] offset:1024
    ds_write_b128 v8, v[56:59] offset:2048
    ds_write_b128 v8, v[60:63] offset:3072
    v_mov_b32 v12, 2
    s_waitcnt lgkmcnt(0)
    ds_write_b32 v7, v12
    v_xor_b32 v10, 16, v7
LB_gw2:
    ds_read_b32 v11, v10 offset:0
    s_waitcnt lgkmcnt(0)
    v_readfirstlane_b32 s37, v11
    s_cmp_ge_u32 s37, 2
    s_cbranch_scc1 LB_gw2_ok
    s_sleep 1
    s_branch LB_gw2
LB_gw2_ok:
    s_xor_b32 s37, s36, 2
    s_lshl_b32 s37, s37, 12
    s_add_u32 s37, s37, 139520
    v_lshlrev_b32 v9, 4, v1
    v_add_u32 v9, s37, v9
    ds_read_b128 v[80:83], v9 offset:0
    ds_read_b128 v[84:87], v9 offset:1024
    ds_read_b128 v[88:91], v9 offset:2048
    ds_read_b128 v[92:95], v9 offset:3072
    s_waitcnt lgkmcnt(0)
    ds_write_b32 v7, v12 offset:4
    v_add_f32 v16, v16, v80
    v_add_f32 v17, v17, v81
    v_add_f32 v18, v18, v82
    v_add_f32 v19, v19, v83
    v_add_f32 v20, v20, v84
    v_add_f32 v21, v21, v85
    v_add_f32 v22, v22, v86
    v_add_f32 v23, v23, v87
    v_add_f32 v24, v24, v88
    v_add_f32 v25, v25, v89
    v_add_f32 v26, v26, v90
    v_add_f32 v27, v27, v91
    v_add_f32 v28, v28, v92
    v_add_f32 v29, v29, v93
    v_add_f32 v30, v30, v94
    v_add_f32 v31, v31, v95
    v_xor_b32 v10, 16, v7
LB_gc3:
    ds_read_b32 v11, v10 offset:4
    s_waitcnt lgkmcnt(0)
    v_readfirstlane_b32 s37, v11
    s_cmp_ge_u32 s37, 2
    s_cbranch_scc1 LB_gc3_ok
    s_sleep 1
    s_branch LB_gc3
LB_gc3_ok:
    ds_write_b128 v8, v[64:67] offset:0
    ds_write_b128 v8, v[68:71] offset:1024
    ds_write_b128 v8, v[72:75] offset:2048
    ds_write_b128 v8, v[76:79] offset:3072
    v_mov_b32 v12, 3
    s_waitcnt lgkmcnt(0)
    ds_write_b32 v7, v12
    v_xor_b32 v10, 24, v7
LB_gw3:
    ds_read_b32 v11, v10 offset:0
    s_waitcnt lgkmcnt(0)
    v_readfirstlane_b32 s37, v11
    s_cmp_ge_u32 s37, 3
    s_cbranch_scc1 LB_gw3_ok
    s_sleep 1
    s_branch LB_gw3
LB_gw3_ok:
    s_xor_b32 s37, s36, 3
    s_lshl_b32 s37, s37, 12
    s_add_u32 s37, s37, 139520
    v_lshlrev_b32 v9, 4, v1
    v_add_u32 v9, s37, v9
    ds_read_b128 v[80:83], v9 offset:0
    ds_read_b128 v[84:87], v9 offset:1024
    ds_read_b128 v[88:91], v9 offset:2048
    ds_read_b128 v[92:95], v9 offset:3072
    s_waitcnt lgkmcnt(0)
    v_add_f32 v16, v16, v80
    v_add_f32 v17, v17, v81
    v_add_f32 v18, v18, v82
    v_add_f32 v19, v19, v83
    v_add_f32 v20, v20, v84
    v_add_f32 v21, v21, v85
    v_add_f32 v22, v22, v86
    v_add_f32 v23, v23, v87
    v_add_f32 v24, v24, v88
    v_add_f32 v25, v25, v89
    v_add_f32 v26, v26, v90
    v_add_f32 v27, v27, v91
    v_add_f32 v28, v28, v92
    v_add_f32 v29, v29, v93
    v_add_f32 v30, v30, v94
    v_add_f32 v31, v31, v95
    v_lshlrev_b32 v4, 4, v1
    s_lshl_b32 s27, s2, 2
    s_add_u32 s27, s27, s26
    s_sub_u32 s27, s27, 8
    s_lshl_b32 s27, s27, 11
    s_nop 15
    s_nop 3
    v_cvt_pk_bf16_f32 v8, v16, v17
    v_cvt_pk_bf16_f32 v9, v18, v19
    v_cvt_pk_bf16_f32 v10, v20, v21
    v_cvt_pk_bf16_f32 v11, v22, v23
    v_cvt_pk_bf16_f32 v12, v24, v25
    v_cvt_pk_bf16_f32 v13, v26, v27
    v_cvt_pk_bf16_f32 v14, v28, v29
    v_cvt_pk_bf16_f32 v15, v30, v31
    buffer_store_dwordx4 v[8:11], v4, s[16:19], s27 offen offset:0 sc1
    buffer_store_dwordx4 v[12:15], v4, s[16:19], s27 offen offset:1024 sc1
    s_sub_u32 s26, s26, 8
    s_endpgm
.globl outgemm_kernel
.p2align 8
.type outgemm_kernel,@function
outgemm_kernel:
    s_cmp_ge_u32 s2, 256
    s_cbranch_scc1 LC_exit
    s_load_dwordx2 s[8:9], s[0:1], 48
    s_load_dwordx2 s[10:11], s[0:1], 64
    v_and_b32 v1, 63, v0
    v_lshrrev_b32 v2, 6, v0
    s_nop 0
    v_readfirstlane_b32 s26, v2
    s_and_b32 s24, s2, 7
    s_lshl_b32 s24, s24, 2
    s_bfe_u32 s25, s2, 0x20003
    s_add_u32 s24, s24, s25
    s_lshr_b32 s25, s2, 5
    v_and_b32 v2, 31, v1
    v_lshrrev_b32 v3, 5, v1
    s_lshl_b32 s24, s24, 6
    s_lshl_b32 s25, s25, 6
    s_and_b32 s27, s26, 1
    s_lshl_b32 s27, s27, 5
    s_cmp_lt_u32 s26, 2
    s_cselect_b32 s28, s25, s24
    s_add_u32 s28, s28, s27
    s_mov_b32 s29, 32768
    s_mov_b32 s30, 8388608
    s_mov_b32 s14, 9437184
    s_cmp_lt_u32 s26, 2
    s_cselect_b32 s29, 8192, s29
    s_cselect_b32 s30, 20971520, s30
    s_cselect_b32 s14, 2359296, s14
    v_add_u32 v4, s28, v2
    v_lshlrev_b32 v4, 4, v4
    v_mul_lo_u32 v5, v3, s29
    v_add_u32 v4, v4, v5
    s_lshl_b32 s29, s29, 1
    s_lshl_b32 s31, s26, 10
    s_add_u32 s27, s27, s24
    v_add_u32 v7, s27, v2
    v_lshlrev_b32 v6, 10, v7
    v_lshl_add_u32 v6, v3, 4, v6
    s_lshr_b32 s27, s26, 1
    s_lshl_b32 s32, s27, 10
    v_lshlrev_b32 v8, 4, v1
    v_add_u32 v9, s32, v8
    s_and_b32 s32, s26, 1
    s_lshl_b32 s32, s32, 10
    s_add_u32 s32, s32, 2048
    v_add_u32 v10, s32, v8
    v_add_u32 v11, 65536, v9
    v_add_u32 v12, 65536, v10
    s_lshl_b32 s27, s27, 5
    s_add_u32 s27, s27, s25
    s_lshl_b32 s27, s27, 1
    s_lshl_b32 s33, s2, 2
    s_add_u32 s33, s33, s26
    s_lshl_b32 s33, s33, 11
    s_waitcnt lgkmcnt(0)
    s_add_u32 s12, s10, s30
    s_addc_u32 s13, s11, 0
    s_mov_b32 s15, 0x00020000
    s_add_u32 s16, s10, 25165824
    s_addc_u32 s17, s11, 0
    s_mov_b32 s18, 4194304
    s_mov_b32 s19, 0x00020000
    s_mov_b32 s40, s8
    s_mov_b32 s41, s9
    s_mov_b32 s42, 2097152
    s_mov_b32 s43, 0x00020000
    s_mov_b32 s28, 0
    s_mov_b32 m0, s31
    buffer_load_dwordx4 v4, s[12:15], s28 offen lds
    s_add_u32 s28, s28, s29
    s_add_u32 m0, m0, 4096
    buffer_load_dwordx4 v4, s[12:15], s28 offen lds
    s_add_u32 s28, s28, s29
    s_add_u32 m0, m0, 4096
    buffer_load_dwordx4 v4, s[12:15], s28 offen lds
    s_add_u32 s28, s28, s29
    s_add_u32 m0, m0, 4096
    buffer_load_dwordx4 v4, s[12:15], s28 offen lds
    s_add_u32 s28, s28, s29
    s_add_u32 m0, m0, 4096
    buffer_load_dwordx4 v[64:67], v8, s[16:19], s33 offen offset:0
    buffer_load_dwordx4 v[68:71], v8, s[16:19], s33 offen offset:1024
    buffer_load_dwordx4 v4, s[12:15], s28 offen lds
    s_add_u32 s28, s28, s29
    s_add_u32 m0, m0, 4096
    buffer_load_dwordx4 v4, s[12:15], s28 offen lds
    s_add_u32 s28, s28, s29
    s_add_u32 m0, m0, 4096
    buffer_load_dwordx4 v4, s[12:15], s28 offen lds
    s_add_u32 s28, s28, s29
    s_add_u32 m0, m0, 4096
    buffer_load_dwordx4 v4, s[12:15], s28 offen lds
    s_add_u32 s28, s28, s29
    s_add_u32 m0, m0, 4096
    buffer_load_dwordx4 v4, s[12:15], s28 offen lds
    s_add_u32 s28, s28, s29
    s_add_u32 m0, m0, 4096
    buffer_load_dwordx4 v4, s[12:15], s28 offen lds
    s_add_u32 s28, s28, s29
    s_add_u32 m0, m0, 4096
    buffer_load_dwordx4 v4, s[12:15], s28 offen lds
    s_add_u32 s28, s28, s29
    s_add_u32 m0, m0, 4096
    buffer_load_dwordx4 v4, s[12:15], s28 offen lds
    s_add_u32 s28, s28, s29
    s_add_u32 m0, m0, 4096
    buffer_load_dwordx4 v4, s[12:15], s28 offen lds
    s_add_u32 s28, s28, s29
    s_add_u32 m0, m0, 4096
    buffer_load_dwordx4 v4, s[12:15], s28 offen lds
    s_add_u32 s28, s28, s29
    s_add_u32 m0, m0, 4096
    buffer_load_dwordx4 v4, s[12:15], s28 offen lds
    s_add_u32 s28, s28, s29
    s_add_u32 m0, m0, 4096
    buffer_load_dwordx4 v4, s[12:15], s28 offen lds
    s_add_u32 s28, s28, s29
    s_add_u32 m0, m0, 4096
    s_waitcnt vmcnt(12)
    s_barrier
    ds_read_b128 v[32:35], v9 offset:0
    ds_read_b128 v[36:39], v10 offset:0
    ds_read_b128 v[40:43], v9 offset:4096
    ds_read_b128 v[44:47], v10 offset:4096
    ds_read_b128 v[48:51], v9 offset:8192
    ds_read_b128 v[52:55], v10 offset:8192
    ds_read_b128 v[56:59], v9 offset:12288
    ds_read_b128 v[60:63], v10 offset:12288
    buffer_load_dwordx4 v4, s[12:15], s28 offen lds
    s_add_u32 s28, s28, s29
    s_add_u32 m0, m0, 4096
    buffer_load_dwordx4 v4, s[12:15], s28 offen lds
    s_add_u32 s28, s28, s29
    s_add_u32 m0, m0, 4096
    buffer_load_dwordx4 v4, s[12:15], s28 offen lds
    s_add_u32 s28, s28, s29
    s_add_u32 m0, m0, 4096
    buffer_load_dwordx4 v4, s[12:15], s28 offen lds
    s_add_u32 s28, s28, s29
    s_add_u32 m0, m0, 4096
    v_lshlrev_b32 v16, 16, v64
    v_and_b32 v17, 0xffff0000, v64
    v_lshlrev_b32 v18, 16, v65
    v_and_b32 v19, 0xffff0000, v65
    v_lshlrev_b32 v20, 16, v66
    v_and_b32 v21, 0xffff0000, v66
    v_lshlrev_b32 v22, 16, v67
    v_and_b32 v23, 0xffff0000, v67
    v_lshlrev_b32 v24, 16, v68
    v_and_b32 v25, 0xffff0000, v68
    v_lshlrev_b32 v26, 16, v69
    v_and_b32 v27, 0xffff0000, v69
    v_lshlrev_b32 v28, 16, v70
    v_and_b32 v29, 0xffff0000, v70
    v_lshlrev_b32 v30, 16, v71
    v_and_b32 v31, 0xffff0000, v71
    s_waitcnt lgkmcnt(6)
    v_mfma_f32_32x32x16_bf16 v[16:31], v[32:35], v[36:39], v[16:31]
    s_waitcnt lgkmcnt(4)
    v_mfma_f32_32x32x16_bf16 v[16:31], v[40:43], v[44:47], v[16:31]
    s_waitcnt lgkmcnt(2)
    v_mfma_f32_32x32x16_bf16 v[16:31], v[48:51], v[52:55], v[16:31]
    s_waitcnt lgkmcnt(0)
    v_mfma_f32_32x32x16_bf16 v[16:31], v[56:59], v[60:63], v[16:31]
    s_waitcnt vmcnt(12)
    s_barrier
    ds_read_b128 v[32:35], v9 offset:16384
    ds_read_b128 v[36:39], v10 offset:16384
    ds_read_b128 v[40:43], v9 offset:20480
    ds_read_b128 v[44:47], v10 offset:20480
    ds_read_b128 v[48:51], v9 offset:24576
    ds_read_b128 v[52:55], v10 offset:24576
    ds_read_b128 v[56:59], v9 offset:28672
    ds_read_b128 v[60:63], v10 offset:28672
    buffer_load_dwordx4 v4, s[12:15], s28 offen lds
    s_add_u32 s28, s28, s29
    s_add_u32 m0, m0, 4096
    buffer_load_dwordx4 v4, s[12:15], s28 offen lds
    s_add_u32 s28, s28, s29
    s_add_u32 m0, m0, 4096
    buffer_load_dwordx4 v4, s[12:15], s28 offen lds
    s_add_u32 s28, s28, s29
    s_add_u32 m0, m0, 4096
    buffer_load_dwordx4 v4, s[12:15], s28 offen lds
    s_add_u32 s28, s28, s29
    s_add_u32 m0, m0, 4096
    s_waitcnt lgkmcnt(6)
    v_mfma_f32_32x32x16_bf16 v[16:31], v[32:35], v[36:39], v[16:31]
    s_waitcnt lgkmcnt(4)
    v_mfma_f32_32x32x16_bf16 v[16:31], v[40:43], v[44:47], v[16:31]
    s_waitcnt lgkmcnt(2)
    v_mfma_f32_32x32x16_bf16 v[16:31], v[48:51], v[52:55], v[16:31]
    s_waitcnt lgkmcnt(0)
    v_mfma_f32_32x32x16_bf16 v[16:31], v[56:59], v[60:63], v[16:31]
    s_waitcnt vmcnt(12)
    s_barrier
    ds_read_b128 v[32:35], v9 offset:32768
    ds_read_b128 v[36:39], v10 offset:32768
    ds_read_b128 v[40:43], v9 offset:36864
    ds_read_b128 v[44:47], v10 offset:36864
    ds_read_b128 v[48:51], v9 offset:40960
    ds_read_b128 v[52:55], v10 offset:40960
    ds_read_b128 v[56:59], v9 offset:45056
    ds_read_b128 v[60:63], v10 offset:45056
    buffer_load_dwordx4 v4, s[12:15], s28 offen lds
    s_add_u32 s28, s28, s29
    s_add_u32 m0, m0, 4096
    buffer_load_dwordx4 v4, s[12:15], s28 offen lds
    s_add_u32 s28, s28, s29
    s_add_u32 m0, m0, 4096
    buffer_load_dwordx4 v4, s[12:15], s28 offen lds
    s_add_u32 s28, s28, s29
    s_add_u32 m0, m0, 4096
    buffer_load_dwordx4 v4, s[12:15], s28 offen lds
    s_add_u32 s28, s28, s29
    s_add_u32 m0, m0, 4096
    s_waitcnt lgkmcnt(6)
    v_mfma_f32_32x32x16_bf16 v[16:31], v[32:35], v[36:39], v[16:31]
    s_waitcnt lgkmcnt(4)
    v_mfma_f32_32x32x16_bf16 v[16:31], v[40:43], v[44:47], v[16:31]
    s_waitcnt lgkmcnt(2)
    v_mfma_f32_32x32x16_bf16 v[16:31], v[48:51], v[52:55], v[16:31]
    s_waitcnt lgkmcnt(0)
    v_mfma_f32_32x32x16_bf16 v[16:31], v[56:59], v[60:63], v[16:31]
    s_waitcnt vmcnt(12)
    s_barrier
    ds_read_b128 v[32:35], v9 offset:49152
    ds_read_b128 v[36:39], v10 offset:49152
    ds_read_b128 v[40:43], v9 offset:53248
    ds_read_b128 v[44:47], v10 offset:53248
    ds_read_b128 v[48:51], v9 offset:57344
    ds_read_b128 v[52:55], v10 offset:57344
    ds_read_b128 v[56:59], v9 offset:61440
    ds_read_b128 v[60:63], v10 offset:61440
    buffer_load_dwordx4 v4, s[12:15], s28 offen lds
    s_add_u32 s28, s28, s29
    s_add_u32 m0, m0, 4096
    buffer_load_dwordx4 v4, s[12:15], s28 offen lds
    s_add_u32 s28, s28, s29
    s_add_u32 m0, m0, 4096
    buffer_load_dwordx4 v4, s[12:15], s28 offen lds
    s_add_u32 s28, s28, s29
    s_add_u32 m0, m0, 4096
    buffer_load_dwordx4 v4, s[12:15], s28 offen lds
    s_waitcnt lgkmcnt(6)
    v_mfma_f32_32x32x16_bf16 v[16:31], v[32:35], v[36:39], v[16:31]
    s_waitcnt lgkmcnt(4)
    v_mfma_f32_32x32x16_bf16 v[16:31], v[40:43], v[44:47], v[16:31]
    s_waitcnt lgkmcnt(2)
    v_mfma_f32_32x32x16_bf16 v[16:31], v[48:51], v[52:55], v[16:31]
    s_waitcnt lgkmcnt(0)
    v_mfma_f32_32x32x16_bf16 v[16:31], v[56:59], v[60:63], v[16:31]
    s_waitcnt vmcnt(12)
    s_barrier
    ds_read_b128 v[32:35], v11 offset:0
    ds_read_b128 v[36:39], v12 offset:0
    ds_read_b128 v[40:43], v11 offset:4096
    ds_read_b128 v[44:47], v12 offset:4096
    ds_read_b128 v[48:51], v11 offset:8192
    ds_read_b128 v[52:55], v12 offset:8192
    ds_read_b128 v[56:59], v11 offset:12288
    ds_read_b128 v[60:63], v12 offset:12288
    s_waitcnt lgkmcnt(6)
    v_mfma_f32_32x32x16_bf16 v[16:31], v[32:35], v[36:39], v[16:31]
    s_waitcnt lgkmcnt(4)
    v_mfma_f32_32x32x16_bf16 v[16:31], v[40:43], v[44:47], v[16:31]
    s_waitcnt lgkmcnt(2)
    v_mfma_f32_32x32x16_bf16 v[16:31], v[48:51], v[52:55], v[16:31]
    s_waitcnt lgkmcnt(0)
    v_mfma_f32_32x32x16_bf16 v[16:31], v[56:59], v[60:63], v[16:31]
    s_waitcnt vmcnt(8)
    s_barrier
    ds_read_b128 v[32:35], v11 offset:16384
    ds_read_b128 v[36:39], v12 offset:16384
    ds_read_b128 v[40:43], v11 offset:20480
    ds_read_b128 v[44:47], v12 offset:20480
    ds_read_b128 v[48:51], v11 offset:24576
    ds_read_b128 v[52:55], v12 offset:24576
    ds_read_b128 v[56:59], v11 offset:28672
    ds_read_b128 v[60:63], v12 offset:28672
    s_waitcnt lgkmcnt(6)
    v_mfma_f32_32x32x16_bf16 v[16:31], v[32:35], v[36:39], v[16:31]
    s_waitcnt lgkmcnt(4)
    v_mfma_f32_32x32x16_bf16 v[16:31], v[40:43], v[44:47], v[16:31]
    s_waitcnt lgkmcnt(2)
    v_mfma_f32_32x32x16_bf16 v[16:31], v[48:51], v[52:55], v[16:31]
    s_waitcnt lgkmcnt(0)
    v_mfma_f32_32x32x16_bf16 v[16:31], v[56:59], v[60:63], v[16:31]
    s_waitcnt vmcnt(4)
    s_barrier
    ds_read_b128 v[32:35], v11 offset:32768
    ds_read_b128 v[36:39], v12 offset:32768
    ds_read_b128 v[40:43], v11 offset:36864
    ds_read_b128 v[44:47], v12 offset:36864
    ds_read_b128 v[48:51], v11 offset:40960
    ds_read_b128 v[52:55], v12 offset:40960
    ds_read_b128 v[56:59], v11 offset:45056
    ds_read_b128 v[60:63], v12 offset:45056
    s_waitcnt lgkmcnt(6)
    v_mfma_f32_32x32x16_bf16 v[16:31], v[32:35], v[36:39], v[16:31]
    s_waitcnt lgkmcnt(4)
    v_mfma_f32_32x32x16_bf16 v[16:31], v[40:43], v[44:47], v[16:31]
    s_waitcnt lgkmcnt(2)
    v_mfma_f32_32x32x16_bf16 v[16:31], v[48:51], v[52:55], v[16:31]
    s_waitcnt lgkmcnt(0)
    v_mfma_f32_32x32x16_bf16 v[16:31], v[56:59], v[60:63], v[16:31]
    s_waitcnt vmcnt(0)
    s_barrier
    ds_read_b128 v[32:35], v11 offset:49152
    ds_read_b128 v[36:39], v12 offset:49152
    ds_read_b128 v[40:43], v11 offset:53248
    ds_read_b128 v[44:47], v12 offset:53248
    ds_read_b128 v[48:51], v11 offset:57344
    ds_read_b128 v[52:55], v12 offset:57344
    ds_read_b128 v[56:59], v11 offset:61440
    ds_read_b128 v[60:63], v12 offset:61440
    s_waitcnt lgkmcnt(6)
    v_mfma_f32_32x32x16_bf16 v[16:31], v[32:35], v[36:39], v[16:31]
    s_waitcnt lgkmcnt(4)
    v_mfma_f32_32x32x16_bf16 v[16:31], v[40:43], v[44:47], v[16:31]
    s_waitcnt lgkmcnt(2)
    v_mfma_f32_32x32x16_bf16 v[16:31], v[48:51], v[52:55], v[16:31]
    s_waitcnt lgkmcnt(0)
    v_mfma_f32_32x32x16_bf16 v[16:31], v[56:59], v[60:63], v[16:31]
    s_nop 15
    s_nop 3
    v_cvt_pk_bf16_f32 v32, v16, v17
    v_cvt_pk_bf16_f32 v33, v18, v19
    v_cvt_pk_bf16_f32 v34, v20, v21
    v_cvt_pk_bf16_f32 v35, v22, v23
    v_cvt_pk_bf16_f32 v36, v24, v25
    v_cvt_pk_bf16_f32 v37, v26, v27
    v_cvt_pk_bf16_f32 v38, v28, v29
    v_cvt_pk_bf16_f32 v39, v30, v31
    s_nop 1
    v_permlane32_swap_b32 v32, v34
    v_permlane32_swap_b32 v33, v35
    v_permlane32_swap_b32 v36, v38
    v_permlane32_swap_b32 v37, v39
    buffer_store_dwordx4 v[32:35], v6, s[40:43], s27 offen offset:0
    buffer_store_dwordx4 v[36:39], v6, s[40:43], s27 offen offset:32
LC_exit:
    s_endpgm
.section .rodata,"a"
.p2align 6
.amdhsa_kernel lngemm_kernel
  .amdhsa_next_free_vgpr 356
  .amdhsa_next_free_sgpr 96
  .amdhsa_accum_offset 244
  .amdhsa_group_segment_fixed_size 0
  .amdhsa_kernarg_size 72
  .amdhsa_user_sgpr_count 2
  .amdhsa_user_sgpr_kernarg_segment_ptr 1
  .amdhsa_system_sgpr_workgroup_id_x 1
.end_amdhsa_kernel

.p2align 6
.amdhsa_kernel attn_kernel
  .amdhsa_next_free_vgpr 144
  .amdhsa_next_free_sgpr 96
  .amdhsa_accum_offset 144
  .amdhsa_group_segment_fixed_size 0
  .amdhsa_kernarg_size 72
  .amdhsa_user_sgpr_count 2
  .amdhsa_user_sgpr_kernarg_segment_ptr 1
  .amdhsa_system_sgpr_workgroup_id_x 1
.end_amdhsa_kernel

.p2align 6
.amdhsa_kernel outgemm_kernel
  .amdhsa_next_free_vgpr 72
  .amdhsa_next_free_sgpr 96
  .amdhsa_accum_offset 72
  .amdhsa_group_segment_fixed_size 0
  .amdhsa_kernarg_size 72
  .amdhsa_user_sgpr_count 2
  .amdhsa_user_sgpr_kernarg_segment_ptr 1
  .amdhsa_system_sgpr_workgroup_id_x 1
.end_amdhsa_kernel
```
